```python
import torch

def _softmax(x, axis=-1):
    return torch.softmax(x, dim=axis)
def _gelu(x):
    return torch.nn.functional.gelu(x, approximate="tanh")
def _silu(x):
    return torch.nn.functional.silu(x)
def _sigmoid(x):
    return torch.sigmoid(x)
def _layernorm(x, axis=-1, eps=1e-5):
    m = x.mean(dim=axis, keepdim=True)
    v = x.var(dim=axis, keepdim=True, unbiased=False)
    return (x - m) / torch.sqrt(v + eps)
def _scatter_add(tgt, idx, src, axis=0):
    return tgt.clone().index_add_(axis, idx, src)
def _segment_sum(src, seg, n):
    out = torch.zeros((n,) + src.shape[1:], dtype=src.dtype)
    return out.index_add_(0, seg, src)
def _pad(x, pw):
    flat = tuple(v for pair in reversed(pw) for v in pair)
    return torch.nn.functional.pad(x, flat)

kernel_name = 'parallel_sum__softmax_full_mha__dense_activation_squared_relu__prompt'

def setup_inputs():

    _w = (lambda a: (lambda t: t.to(torch.bfloat16) if t.is_floating_point() else t)(torch.as_tensor(a)))
    def _A_setup():
        B, S, D = 1, 2048, 512
        return {
            "x": _w((lambda *s: torch.randn(*s, dtype=torch.bfloat16) * 0.05)(B, S, D)),
            "wqkv": _w((lambda *s: torch.randn(*s, dtype=torch.bfloat16) * 0.2)(D, 3 * D)),
            "wo": _w((lambda *s: torch.randn(*s, dtype=torch.bfloat16) * 0.1)(D, D)),
        }
    _A_in = _A_setup()

    def _B_setup():
        B, S, D, F = 1, 2048, 512, 1792
        return {
            "x": _w((lambda *s: torch.randn(*s, dtype=torch.bfloat16) * 0.05)(B, S, D)),
            "w1": _w((lambda *s: torch.randn(*s, dtype=torch.bfloat16) * 0.1)(D, F)),
            "b1": _w((lambda *s: torch.randn(*s, dtype=torch.bfloat16) * 0.8)(F)),
            "w2": _w((lambda *s: torch.randn(*s, dtype=torch.bfloat16) * 0.1)(F, D)),
            "b2": _w((lambda *s: torch.randn(*s, dtype=torch.bfloat16) * 12.8)(D)),
        }
    _B_in = _B_setup()

    return {
        "A_x": _A_in["x"],
        "A_wqkv": _A_in["wqkv"],
        "A_wo": _A_in["wo"],
        "B_x": _B_in["x"],
        "B_w1": _B_in["w1"],
        "B_b1": _B_in["b1"],
        "B_w2": _B_in["w2"],
        "B_b2": _B_in["b2"],
    }

def reference(A_x, A_wqkv, A_wo, B_x, B_w1, B_b1, B_w2, B_b2):
    def _A_ref(x, wqkv, wo):
        B, S, D = x.shape
        H = 32; Dh = D // H
        qkv = (lambda x, *d: x.permute(*d))((x @ wqkv).reshape(B, S, 3, H, Dh), 2, 0, 3, 1, 4)
        q, k, v = qkv[0], qkv[1], qkv[2]
        scale = Dh ** -0.5
        scores = torch.einsum("bhqd,bhkd->bhqk", q, k) * scale
        p = _softmax(scores, axis=-1)
        o = torch.einsum("bhqk,bhkd->bhqd", p, v)
        return (lambda x, *d: x.permute(*d))(o, 0, 2, 1, 3).reshape(B, S, D) @ wo

    def _B_ref(x, w1, b1, w2, b2):
        h = torch.einsum("bsd,df->bsf", x, w1) + b1
        zero = torch.zeros_like(h)
        r = torch.where(h > zero, h, zero)
        h = r * r
        out = torch.einsum("bsf,fd->bsd", h, w2) + b2
        return out

    x = A_x
    xn = _layernorm(x, axis=-1)
    return x + _A_ref(xn, A_wqkv, A_wo) + _B_ref(xn, B_w1, B_b1, B_w2, B_b2)
```

```asm
; @launch grid=(256,1,1) block=(768,1,1) lds=163840
.amdgcn_target "amdgcn-amd-amdhsa--gfx950"
.text
.p2align 8
.globl parallel_sum__softmax_full_mha__dense_activation_squared_relu__prompt_kernel
.type parallel_sum__softmax_full_mha__dense_activation_squared_relu__prompt_kernel,@function
parallel_sum__softmax_full_mha__dense_activation_squared_relu__prompt_kernel:
    s_cmp_ge_u32 s2, 256
    s_cbranch_scc1 parallel_end
    s_load_dwordx4 s[64:67], s[0:1], 0
    s_load_dwordx2 s[68:69], s[0:1], 16
    s_load_dwordx8 s[72:79], s[0:1], 32
    s_load_dwordx4 s[80:83], s[0:1], 64
    s_load_dwordx2 s[84:85], s[0:1], 80
    v_lshrrev_b32 v1, 6, v0
    v_and_b32 v0, 63, v0
    v_readfirstlane_b32 s86, v1
    s_mov_b32 s87, s2
    s_mov_b32 s96, 255
    s_mov_b32 s97, 255
    s_and_b32 s3, s87, 7
    s_lshr_b32 s4, s87, 3
    s_cmp_lt_u32 s3, 4
    s_cbranch_scc1 parallel_proj
    s_cmp_lt_u32 s4, 28
    s_cbranch_scc1 parallel_proj
    s_sub_u32 s4, s4, 28
    s_lshl_b32 s4, s4, 2
    s_add_u32 s4, s4, s3
    s_sub_u32 s96, s4, 4
    s_branch parallel_helper
parallel_proj:
    s_and_b32 s3, s87, 7
    s_lshr_b32 s55, s87, 3
    s_lshr_b32 s56, s3, 1
    s_mul_i32 s56, s56, 28
    s_sub_u32 s56, s56, 8
    s_cmp_lt_u32 s3, 4
    s_cselect_b32 s56, 0, s56
    s_add_u32 s56, s56, s55
    s_lshr_b32 s43, s56, 3
    s_and_b32 s44, s3, 1
    s_lshl_b32 s44, s44, 3
    s_and_b32 s56, s56, 7
    s_add_u32 s44, s44, s56
    s_cmp_ge_u32 s3, 4
    s_cbranch_scc1 parallel_isH
    s_lshr_b32 s56, s3, 1
    s_lshl_b32 s56, s56, 2
    s_add_u32 s45, s56, s43
    s_mov_b32 s43, 0
parallel_isH:
    s_cmp_ge_u32 s86, 8
    s_cbranch_scc1 parallel_loader
    s_lshr_b32 s41, s86, 2
    s_and_b32 s42, s86, 3
    s_lshl_b32 s46, s43, 4
    s_lshl_b32 s58, s42, 2
    s_add_u32 s46, s46, s58
    s_lshl_b32 s41, s41, 6
    s_cmp_ge_u32 s43, 6
    s_cbranch_scc1 parallel_mmH
    s_cmp_ge_u32 s86, 6
    s_cbranch_scc1 parallel_idle1
    s_and_b32 s41, s86, 1
    s_lshl_b32 s41, s41, 6
    s_lshr_b32 s42, s86, 1
    s_lshl_b32 s46, s42, 5
    s_lshl_b32 s58, s45, 2
    s_add_u32 s46, s46, s58
parallel_mmH:
    v_and_b32 v1, 31, v0
    v_add_u32 v1, s41, v1
    v_lshrrev_b32 v2, 1, v1
    v_and_b32 v2, 7, v2
    v_lshrrev_b32 v3, 5, v0
    v_xor_b32 v2, v2, v3
    v_lshlrev_b32 v2, 4, v2
    v_lshl_add_u32 v2, v1, 7, v2
    v_xor_b32 v8, 0, v2
    v_xor_b32 v9, 32, v2
    v_xor_b32 v10, 64, v2
    v_xor_b32 v11, 96, v2
    v_and_b32 v1, 15, v0
    v_lshrrev_b32 v1, 2, v1
    v_lshl_add_u32 v4, v3, 3, v1
    v_bfe_u32 v5, v0, 4, 1
    v_lshlrev_b32 v5, 5, v5
    v_and_b32 v6, 3, v0
    v_lshl_add_u32 v5, v6, 3, v5
    v_lshrrev_b32 v1, 1, v1
    v_lshl_add_u32 v5, v1, 6, v5
    v_lshl_add_u32 v6, v4, 7, v5
    s_lshl_b32 s58, s42, 13
    s_add_u32 s58, s58, 16384
    v_add_u32 v12, s58, v6
    v_xor_b32 v13, 64, v12
    v_mov_b32 v48, 0
    v_mov_b32 v49, 0
    v_mov_b32 v50, 0
    v_mov_b32 v51, 0
    v_mov_b32 v52, 0
    v_mov_b32 v53, 0
    v_mov_b32 v54, 0
    v_mov_b32 v55, 0
    v_mov_b32 v56, 0
    v_mov_b32 v57, 0
    v_mov_b32 v58, 0
    v_mov_b32 v59, 0
    v_mov_b32 v60, 0
    v_mov_b32 v61, 0
    v_mov_b32 v62, 0
    v_mov_b32 v63, 0
    v_mov_b32 v64, 0
    v_mov_b32 v65, 0
    v_mov_b32 v66, 0
    v_mov_b32 v67, 0
    v_mov_b32 v68, 0
    v_mov_b32 v69, 0
    v_mov_b32 v70, 0
    v_mov_b32 v71, 0
    v_mov_b32 v72, 0
    v_mov_b32 v73, 0
    v_mov_b32 v74, 0
    v_mov_b32 v75, 0
    v_mov_b32 v76, 0
    v_mov_b32 v77, 0
    v_mov_b32 v78, 0
    v_mov_b32 v79, 0
    v_mov_b32 v80, 0
    v_mov_b32 v81, 0
    v_mov_b32 v82, 0
    v_mov_b32 v83, 0
    v_mov_b32 v84, 0
    v_mov_b32 v85, 0
    v_mov_b32 v86, 0
    v_mov_b32 v87, 0
    v_mov_b32 v88, 0
    v_mov_b32 v89, 0
    v_mov_b32 v90, 0
    v_mov_b32 v91, 0
    v_mov_b32 v92, 0
    v_mov_b32 v93, 0
    v_mov_b32 v94, 0
    v_mov_b32 v95, 0
    v_mov_b32 v96, 0
    v_mov_b32 v97, 0
    v_mov_b32 v98, 0
    v_mov_b32 v99, 0
    v_mov_b32 v100, 0
    v_mov_b32 v101, 0
    v_mov_b32 v102, 0
    v_mov_b32 v103, 0
    v_mov_b32 v104, 0
    v_mov_b32 v105, 0
    v_mov_b32 v106, 0
    v_mov_b32 v107, 0
    v_mov_b32 v108, 0
    v_mov_b32 v109, 0
    v_mov_b32 v110, 0
    v_mov_b32 v111, 0
    s_waitcnt lgkmcnt(0)
    s_mov_b32 s24, s84
    s_mov_b32 s25, s85
    s_mov_b32 s26, 18956288
    s_mov_b32 s27, 0x20000
    s_mov_b32 s28, s74
    s_mov_b32 s29, s75
    s_mov_b32 s30, 3584
    s_mov_b32 s31, 0x20000
    s_cmp_lt_u32 s46, 64
    s_cbranch_scc1 parallel_QK
    s_cmp_lt_u32 s46, 96
    s_cbranch_scc1 parallel_V
parallel_H:
    s_barrier
    ds_read_b128 v[16:19], v8 offset:0
    ds_read_b128 v[20:23], v8 offset:4096
    ds_read_b64_tr_b16 v[32:33], v12 offset:0
    ds_read_b64_tr_b16 v[34:35], v12 offset:512
    ds_read_b64_tr_b16 v[36:37], v13 offset:0
    ds_read_b64_tr_b16 v[38:39], v13 offset:512
    s_waitcnt lgkmcnt(0)
    v_mfma_f32_32x32x16_bf16 v[48:63], v[32:35], v[16:19], v[48:63]
    ds_read_b128 v[24:27], v9 offset:0
    ds_read_b128 v[28:31], v9 offset:4096
    v_mfma_f32_32x32x16_bf16 v[64:79], v[36:39], v[16:19], v[64:79]
    ds_read_b64_tr_b16 v[40:41], v12 offset:2048
    ds_read_b64_tr_b16 v[42:43], v12 offset:2560
    v_mfma_f32_32x32x16_bf16 v[80:95], v[32:35], v[20:23], v[80:95]
    ds_read_b64_tr_b16 v[44:45], v13 offset:2048
    ds_read_b64_tr_b16 v[46:47], v13 offset:2560
    v_mfma_f32_32x32x16_bf16 v[96:111], v[36:39], v[20:23], v[96:111]
    s_waitcnt lgkmcnt(0)
    v_mfma_f32_32x32x16_bf16 v[48:63], v[40:43], v[24:27], v[48:63]
    ds_read_b128 v[16:19], v10 offset:0
    ds_read_b128 v[20:23], v10 offset:4096
    v_mfma_f32_32x32x16_bf16 v[64:79], v[44:47], v[24:27], v[64:79]
    ds_read_b64_tr_b16 v[32:33], v12 offset:4096
    ds_read_b64_tr_b16 v[34:35], v12 offset:4608
    v_mfma_f32_32x32x16_bf16 v[80:95], v[40:43], v[28:31], v[80:95]
    ds_read_b64_tr_b16 v[36:37], v13 offset:4096
    ds_read_b64_tr_b16 v[38:39], v13 offset:4608
    v_mfma_f32_32x32x16_bf16 v[96:111], v[44:47], v[28:31], v[96:111]
    s_waitcnt lgkmcnt(0)
    v_mfma_f32_32x32x16_bf16 v[48:63], v[32:35], v[16:19], v[48:63]
    ds_read_b128 v[24:27], v11 offset:0
    ds_read_b128 v[28:31], v11 offset:4096
    v_mfma_f32_32x32x16_bf16 v[64:79], v[36:39], v[16:19], v[64:79]
    ds_read_b64_tr_b16 v[40:41], v12 offset:6144
    ds_read_b64_tr_b16 v[42:43], v12 offset:6656
    v_mfma_f32_32x32x16_bf16 v[80:95], v[32:35], v[20:23], v[80:95]
    ds_read_b64_tr_b16 v[44:45], v13 offset:6144
    ds_read_b64_tr_b16 v[46:47], v13 offset:6656
    v_mfma_f32_32x32x16_bf16 v[96:111], v[36:39], v[20:23], v[96:111]
    s_waitcnt lgkmcnt(0)
    s_barrier
    v_add_u32 v8, 0xc000, v8
    v_add_u32 v9, 0xc000, v9
    v_add_u32 v10, 0xc000, v10
    v_add_u32 v11, 0xc000, v11
    v_add_u32 v12, 0xc000, v12
    v_add_u32 v13, 0xc000, v13
    v_mfma_f32_32x32x16_bf16 v[48:63], v[40:43], v[24:27], v[48:63]
    ds_read_b128 v[16:19], v8 offset:0
    ds_read_b128 v[20:23], v8 offset:4096
    v_mfma_f32_32x32x16_bf16 v[64:79], v[44:47], v[24:27], v[64:79]
    ds_read_b64_tr_b16 v[32:33], v12 offset:0
    ds_read_b64_tr_b16 v[34:35], v12 offset:512
    v_mfma_f32_32x32x16_bf16 v[80:95], v[40:43], v[28:31], v[80:95]
    ds_read_b64_tr_b16 v[36:37], v13 offset:0
    ds_read_b64_tr_b16 v[38:39], v13 offset:512
    v_mfma_f32_32x32x16_bf16 v[96:111], v[44:47], v[28:31], v[96:111]
    s_waitcnt lgkmcnt(0)
    v_mfma_f32_32x32x16_bf16 v[48:63], v[32:35], v[16:19], v[48:63]
    ds_read_b128 v[24:27], v9 offset:0
    ds_read_b128 v[28:31], v9 offset:4096
    v_mfma_f32_32x32x16_bf16 v[64:79], v[36:39], v[16:19], v[64:79]
    ds_read_b64_tr_b16 v[40:41], v12 offset:2048
    ds_read_b64_tr_b16 v[42:43], v12 offset:2560
    v_mfma_f32_32x32x16_bf16 v[80:95], v[32:35], v[20:23], v[80:95]
    ds_read_b64_tr_b16 v[44:45], v13 offset:2048
    ds_read_b64_tr_b16 v[46:47], v13 offset:2560
    v_mfma_f32_32x32x16_bf16 v[96:111], v[36:39], v[20:23], v[96:111]
    s_waitcnt lgkmcnt(0)
    v_mfma_f32_32x32x16_bf16 v[48:63], v[40:43], v[24:27], v[48:63]
    ds_read_b128 v[16:19], v10 offset:0
    ds_read_b128 v[20:23], v10 offset:4096
    v_mfma_f32_32x32x16_bf16 v[64:79], v[44:47], v[24:27], v[64:79]
    ds_read_b64_tr_b16 v[32:33], v12 offset:4096
    ds_read_b64_tr_b16 v[34:35], v12 offset:4608
    v_mfma_f32_32x32x16_bf16 v[80:95], v[40:43], v[28:31], v[80:95]
    ds_read_b64_tr_b16 v[36:37], v13 offset:4096
    ds_read_b64_tr_b16 v[38:39], v13 offset:4608
    v_mfma_f32_32x32x16_bf16 v[96:111], v[44:47], v[28:31], v[96:111]
    s_waitcnt lgkmcnt(0)
    v_mfma_f32_32x32x16_bf16 v[48:63], v[32:35], v[16:19], v[48:63]
    ds_read_b128 v[24:27], v11 offset:0
    ds_read_b128 v[28:31], v11 offset:4096
    v_mfma_f32_32x32x16_bf16 v[64:79], v[36:39], v[16:19], v[64:79]
    ds_read_b64_tr_b16 v[40:41], v12 offset:6144
    ds_read_b64_tr_b16 v[42:43], v12 offset:6656
    v_mfma_f32_32x32x16_bf16 v[80:95], v[32:35], v[20:23], v[80:95]
    ds_read_b64_tr_b16 v[44:45], v13 offset:6144
    ds_read_b64_tr_b16 v[46:47], v13 offset:6656
    v_mfma_f32_32x32x16_bf16 v[96:111], v[36:39], v[20:23], v[96:111]
    s_waitcnt lgkmcnt(0)
    s_barrier
    v_add_u32 v8, 0xc000, v8
    v_add_u32 v9, 0xc000, v9
    v_add_u32 v10, 0xc000, v10
    v_add_u32 v11, 0xc000, v11
    v_add_u32 v12, 0xc000, v12
    v_add_u32 v13, 0xc000, v13
    v_mfma_f32_32x32x16_bf16 v[48:63], v[40:43], v[24:27], v[48:63]
    ds_read_b128 v[16:19], v8 offset:0
    ds_read_b128 v[20:23], v8 offset:4096
    v_mfma_f32_32x32x16_bf16 v[64:79], v[44:47], v[24:27], v[64:79]
    ds_read_b64_tr_b16 v[32:33], v12 offset:0
    ds_read_b64_tr_b16 v[34:35], v12 offset:512
    v_mfma_f32_32x32x16_bf16 v[80:95], v[40:43], v[28:31], v[80:95]
    ds_read_b64_tr_b16 v[36:37], v13 offset:0
    ds_read_b64_tr_b16 v[38:39], v13 offset:512
    v_mfma_f32_32x32x16_bf16 v[96:111], v[44:47], v[28:31], v[96:111]
    s_waitcnt lgkmcnt(0)
    v_mfma_f32_32x32x16_bf16 v[48:63], v[32:35], v[16:19], v[48:63]
    ds_read_b128 v[24:27], v9 offset:0
    ds_read_b128 v[28:31], v9 offset:4096
    v_mfma_f32_32x32x16_bf16 v[64:79], v[36:39], v[16:19], v[64:79]
    ds_read_b64_tr_b16 v[40:41], v12 offset:2048
    ds_read_b64_tr_b16 v[42:43], v12 offset:2560
    v_mfma_f32_32x32x16_bf16 v[80:95], v[32:35], v[20:23], v[80:95]
    ds_read_b64_tr_b16 v[44:45], v13 offset:2048
    ds_read_b64_tr_b16 v[46:47], v13 offset:2560
    v_mfma_f32_32x32x16_bf16 v[96:111], v[36:39], v[20:23], v[96:111]
    s_waitcnt lgkmcnt(0)
    v_mfma_f32_32x32x16_bf16 v[48:63], v[40:43], v[24:27], v[48:63]
    ds_read_b128 v[16:19], v10 offset:0
    ds_read_b128 v[20:23], v10 offset:4096
    v_mfma_f32_32x32x16_bf16 v[64:79], v[44:47], v[24:27], v[64:79]
    ds_read_b64_tr_b16 v[32:33], v12 offset:4096
    ds_read_b64_tr_b16 v[34:35], v12 offset:4608
    v_mfma_f32_32x32x16_bf16 v[80:95], v[40:43], v[28:31], v[80:95]
    ds_read_b64_tr_b16 v[36:37], v13 offset:4096
    ds_read_b64_tr_b16 v[38:39], v13 offset:4608
    v_mfma_f32_32x32x16_bf16 v[96:111], v[44:47], v[28:31], v[96:111]
    s_waitcnt lgkmcnt(0)
    v_mfma_f32_32x32x16_bf16 v[48:63], v[32:35], v[16:19], v[48:63]
    ds_read_b128 v[24:27], v11 offset:0
    ds_read_b128 v[28:31], v11 offset:4096
    v_mfma_f32_32x32x16_bf16 v[64:79], v[36:39], v[16:19], v[64:79]
    ds_read_b64_tr_b16 v[40:41], v12 offset:6144
    ds_read_b64_tr_b16 v[42:43], v12 offset:6656
    v_mfma_f32_32x32x16_bf16 v[80:95], v[32:35], v[20:23], v[80:95]
    ds_read_b64_tr_b16 v[44:45], v13 offset:6144
    ds_read_b64_tr_b16 v[46:47], v13 offset:6656
    v_mfma_f32_32x32x16_bf16 v[96:111], v[36:39], v[20:23], v[96:111]
    s_waitcnt lgkmcnt(0)
    s_barrier
    v_add_u32 v8, 0xfffe8000, v8
    v_add_u32 v9, 0xfffe8000, v9
    v_add_u32 v10, 0xfffe8000, v10
    v_add_u32 v11, 0xfffe8000, v11
    v_add_u32 v12, 0xfffe8000, v12
    v_add_u32 v13, 0xfffe8000, v13
    v_mfma_f32_32x32x16_bf16 v[48:63], v[40:43], v[24:27], v[48:63]
    ds_read_b128 v[16:19], v8 offset:0
    ds_read_b128 v[20:23], v8 offset:4096
    v_mfma_f32_32x32x16_bf16 v[64:79], v[44:47], v[24:27], v[64:79]
    ds_read_b64_tr_b16 v[32:33], v12 offset:0
    ds_read_b64_tr_b16 v[34:35], v12 offset:512
    v_mfma_f32_32x32x16_bf16 v[80:95], v[40:43], v[28:31], v[80:95]
    ds_read_b64_tr_b16 v[36:37], v13 offset:0
    ds_read_b64_tr_b16 v[38:39], v13 offset:512
    v_mfma_f32_32x32x16_bf16 v[96:111], v[44:47], v[28:31], v[96:111]
    s_waitcnt lgkmcnt(0)
    v_mfma_f32_32x32x16_bf16 v[48:63], v[32:35], v[16:19], v[48:63]
    ds_read_b128 v[24:27], v9 offset:0
    ds_read_b128 v[28:31], v9 offset:4096
    v_mfma_f32_32x32x16_bf16 v[64:79], v[36:39], v[16:19], v[64:79]
    ds_read_b64_tr_b16 v[40:41], v12 offset:2048
    ds_read_b64_tr_b16 v[42:43], v12 offset:2560
    v_mfma_f32_32x32x16_bf16 v[80:95], v[32:35], v[20:23], v[80:95]
    ds_read_b64_tr_b16 v[44:45], v13 offset:2048
    ds_read_b64_tr_b16 v[46:47], v13 offset:2560
    v_mfma_f32_32x32x16_bf16 v[96:111], v[36:39], v[20:23], v[96:111]
    s_waitcnt lgkmcnt(0)
    v_mfma_f32_32x32x16_bf16 v[48:63], v[40:43], v[24:27], v[48:63]
    ds_read_b128 v[16:19], v10 offset:0
    ds_read_b128 v[20:23], v10 offset:4096
    v_mfma_f32_32x32x16_bf16 v[64:79], v[44:47], v[24:27], v[64:79]
    ds_read_b64_tr_b16 v[32:33], v12 offset:4096
    ds_read_b64_tr_b16 v[34:35], v12 offset:4608
    v_mfma_f32_32x32x16_bf16 v[80:95], v[40:43], v[28:31], v[80:95]
    ds_read_b64_tr_b16 v[36:37], v13 offset:4096
    ds_read_b64_tr_b16 v[38:39], v13 offset:4608
    v_mfma_f32_32x32x16_bf16 v[96:111], v[44:47], v[28:31], v[96:111]
    s_waitcnt lgkmcnt(0)
    v_mfma_f32_32x32x16_bf16 v[48:63], v[32:35], v[16:19], v[48:63]
    ds_read_b128 v[24:27], v11 offset:0
    ds_read_b128 v[28:31], v11 offset:4096
    v_mfma_f32_32x32x16_bf16 v[64:79], v[36:39], v[16:19], v[64:79]
    ds_read_b64_tr_b16 v[40:41], v12 offset:6144
    ds_read_b64_tr_b16 v[42:43], v12 offset:6656
    v_mfma_f32_32x32x16_bf16 v[80:95], v[32:35], v[20:23], v[80:95]
    ds_read_b64_tr_b16 v[44:45], v13 offset:6144
    ds_read_b64_tr_b16 v[46:47], v13 offset:6656
    v_mfma_f32_32x32x16_bf16 v[96:111], v[36:39], v[20:23], v[96:111]
    s_waitcnt lgkmcnt(0)
    s_barrier
    v_add_u32 v8, 0xc000, v8
    v_add_u32 v9, 0xc000, v9
    v_add_u32 v10, 0xc000, v10
    v_add_u32 v11, 0xc000, v11
    v_add_u32 v12, 0xc000, v12
    v_add_u32 v13, 0xc000, v13
    v_mfma_f32_32x32x16_bf16 v[48:63], v[40:43], v[24:27], v[48:63]
    ds_read_b128 v[16:19], v8 offset:0
    ds_read_b128 v[20:23], v8 offset:4096
    v_mfma_f32_32x32x16_bf16 v[64:79], v[44:47], v[24:27], v[64:79]
    ds_read_b64_tr_b16 v[32:33], v12 offset:0
    ds_read_b64_tr_b16 v[34:35], v12 offset:512
    v_mfma_f32_32x32x16_bf16 v[80:95], v[40:43], v[28:31], v[80:95]
    ds_read_b64_tr_b16 v[36:37], v13 offset:0
    ds_read_b64_tr_b16 v[38:39], v13 offset:512
    v_mfma_f32_32x32x16_bf16 v[96:111], v[44:47], v[28:31], v[96:111]
    s_waitcnt lgkmcnt(0)
    v_mfma_f32_32x32x16_bf16 v[48:63], v[32:35], v[16:19], v[48:63]
    ds_read_b128 v[24:27], v9 offset:0
    ds_read_b128 v[28:31], v9 offset:4096
    v_mfma_f32_32x32x16_bf16 v[64:79], v[36:39], v[16:19], v[64:79]
    ds_read_b64_tr_b16 v[40:41], v12 offset:2048
    ds_read_b64_tr_b16 v[42:43], v12 offset:2560
    v_mfma_f32_32x32x16_bf16 v[80:95], v[32:35], v[20:23], v[80:95]
    ds_read_b64_tr_b16 v[44:45], v13 offset:2048
    ds_read_b64_tr_b16 v[46:47], v13 offset:2560
    v_mfma_f32_32x32x16_bf16 v[96:111], v[36:39], v[20:23], v[96:111]
    s_waitcnt lgkmcnt(0)
    v_mfma_f32_32x32x16_bf16 v[48:63], v[40:43], v[24:27], v[48:63]
    ds_read_b128 v[16:19], v10 offset:0
    ds_read_b128 v[20:23], v10 offset:4096
    v_mfma_f32_32x32x16_bf16 v[64:79], v[44:47], v[24:27], v[64:79]
    ds_read_b64_tr_b16 v[32:33], v12 offset:4096
    ds_read_b64_tr_b16 v[34:35], v12 offset:4608
    v_mfma_f32_32x32x16_bf16 v[80:95], v[40:43], v[28:31], v[80:95]
    ds_read_b64_tr_b16 v[36:37], v13 offset:4096
    ds_read_b64_tr_b16 v[38:39], v13 offset:4608
    v_mfma_f32_32x32x16_bf16 v[96:111], v[44:47], v[28:31], v[96:111]
    s_waitcnt lgkmcnt(0)
    v_mfma_f32_32x32x16_bf16 v[48:63], v[32:35], v[16:19], v[48:63]
    ds_read_b128 v[24:27], v11 offset:0
    ds_read_b128 v[28:31], v11 offset:4096
    v_mfma_f32_32x32x16_bf16 v[64:79], v[36:39], v[16:19], v[64:79]
    ds_read_b64_tr_b16 v[40:41], v12 offset:6144
    ds_read_b64_tr_b16 v[42:43], v12 offset:6656
    v_mfma_f32_32x32x16_bf16 v[80:95], v[32:35], v[20:23], v[80:95]
    ds_read_b64_tr_b16 v[44:45], v13 offset:6144
    ds_read_b64_tr_b16 v[46:47], v13 offset:6656
    v_mfma_f32_32x32x16_bf16 v[96:111], v[36:39], v[20:23], v[96:111]
    s_waitcnt lgkmcnt(0)
    s_barrier
    v_add_u32 v8, 0xc000, v8
    v_add_u32 v9, 0xc000, v9
    v_add_u32 v10, 0xc000, v10
    v_add_u32 v11, 0xc000, v11
    v_add_u32 v12, 0xc000, v12
    v_add_u32 v13, 0xc000, v13
    v_mfma_f32_32x32x16_bf16 v[48:63], v[40:43], v[24:27], v[48:63]
    ds_read_b128 v[16:19], v8 offset:0
    ds_read_b128 v[20:23], v8 offset:4096
    v_mfma_f32_32x32x16_bf16 v[64:79], v[44:47], v[24:27], v[64:79]
    ds_read_b64_tr_b16 v[32:33], v12 offset:0
    ds_read_b64_tr_b16 v[34:35], v12 offset:512
    v_mfma_f32_32x32x16_bf16 v[80:95], v[40:43], v[28:31], v[80:95]
    ds_read_b64_tr_b16 v[36:37], v13 offset:0
    ds_read_b64_tr_b16 v[38:39], v13 offset:512
    v_mfma_f32_32x32x16_bf16 v[96:111], v[44:47], v[28:31], v[96:111]
    s_waitcnt lgkmcnt(0)
    v_mfma_f32_32x32x16_bf16 v[48:63], v[32:35], v[16:19], v[48:63]
    ds_read_b128 v[24:27], v9 offset:0
    ds_read_b128 v[28:31], v9 offset:4096
    v_mfma_f32_32x32x16_bf16 v[64:79], v[36:39], v[16:19], v[64:79]
    ds_read_b64_tr_b16 v[40:41], v12 offset:2048
    ds_read_b64_tr_b16 v[42:43], v12 offset:2560
    v_mfma_f32_32x32x16_bf16 v[80:95], v[32:35], v[20:23], v[80:95]
    ds_read_b64_tr_b16 v[44:45], v13 offset:2048
    ds_read_b64_tr_b16 v[46:47], v13 offset:2560
    v_mfma_f32_32x32x16_bf16 v[96:111], v[36:39], v[20:23], v[96:111]
    s_waitcnt lgkmcnt(0)
    v_mfma_f32_32x32x16_bf16 v[48:63], v[40:43], v[24:27], v[48:63]
    ds_read_b128 v[16:19], v10 offset:0
    ds_read_b128 v[20:23], v10 offset:4096
    v_mfma_f32_32x32x16_bf16 v[64:79], v[44:47], v[24:27], v[64:79]
    ds_read_b64_tr_b16 v[32:33], v12 offset:4096
    ds_read_b64_tr_b16 v[34:35], v12 offset:4608
    v_mfma_f32_32x32x16_bf16 v[80:95], v[40:43], v[28:31], v[80:95]
    ds_read_b64_tr_b16 v[36:37], v13 offset:4096
    ds_read_b64_tr_b16 v[38:39], v13 offset:4608
    v_mfma_f32_32x32x16_bf16 v[96:111], v[44:47], v[28:31], v[96:111]
    s_waitcnt lgkmcnt(0)
    v_mfma_f32_32x32x16_bf16 v[48:63], v[32:35], v[16:19], v[48:63]
    ds_read_b128 v[24:27], v11 offset:0
    ds_read_b128 v[28:31], v11 offset:4096
    v_mfma_f32_32x32x16_bf16 v[64:79], v[36:39], v[16:19], v[64:79]
    ds_read_b64_tr_b16 v[40:41], v12 offset:6144
    ds_read_b64_tr_b16 v[42:43], v12 offset:6656
    v_mfma_f32_32x32x16_bf16 v[80:95], v[32:35], v[20:23], v[80:95]
    ds_read_b64_tr_b16 v[44:45], v13 offset:6144
    ds_read_b64_tr_b16 v[46:47], v13 offset:6656
    v_mfma_f32_32x32x16_bf16 v[96:111], v[36:39], v[20:23], v[96:111]
    s_waitcnt lgkmcnt(0)
    s_barrier
    v_add_u32 v8, 0xfffe8000, v8
    v_add_u32 v9, 0xfffe8000, v9
    v_add_u32 v10, 0xfffe8000, v10
    v_add_u32 v11, 0xfffe8000, v11
    v_add_u32 v12, 0xfffe8000, v12
    v_add_u32 v13, 0xfffe8000, v13
    v_mfma_f32_32x32x16_bf16 v[48:63], v[40:43], v[24:27], v[48:63]
    ds_read_b128 v[16:19], v8 offset:0
    ds_read_b128 v[20:23], v8 offset:4096
    v_mfma_f32_32x32x16_bf16 v[64:79], v[44:47], v[24:27], v[64:79]
    ds_read_b64_tr_b16 v[32:33], v12 offset:0
    ds_read_b64_tr_b16 v[34:35], v12 offset:512
    v_mfma_f32_32x32x16_bf16 v[80:95], v[40:43], v[28:31], v[80:95]
    ds_read_b64_tr_b16 v[36:37], v13 offset:0
    ds_read_b64_tr_b16 v[38:39], v13 offset:512
    v_mfma_f32_32x32x16_bf16 v[96:111], v[44:47], v[28:31], v[96:111]
    s_waitcnt lgkmcnt(0)
    v_mfma_f32_32x32x16_bf16 v[48:63], v[32:35], v[16:19], v[48:63]
    ds_read_b128 v[24:27], v9 offset:0
    ds_read_b128 v[28:31], v9 offset:4096
    v_mfma_f32_32x32x16_bf16 v[64:79], v[36:39], v[16:19], v[64:79]
    ds_read_b64_tr_b16 v[40:41], v12 offset:2048
    ds_read_b64_tr_b16 v[42:43], v12 offset:2560
    v_mfma_f32_32x32x16_bf16 v[80:95], v[32:35], v[20:23], v[80:95]
    ds_read_b64_tr_b16 v[44:45], v13 offset:2048
    ds_read_b64_tr_b16 v[46:47], v13 offset:2560
    v_mfma_f32_32x32x16_bf16 v[96:111], v[36:39], v[20:23], v[96:111]
    s_waitcnt lgkmcnt(0)
    v_mfma_f32_32x32x16_bf16 v[48:63], v[40:43], v[24:27], v[48:63]
    ds_read_b128 v[16:19], v10 offset:0
    ds_read_b128 v[20:23], v10 offset:4096
    v_mfma_f32_32x32x16_bf16 v[64:79], v[44:47], v[24:27], v[64:79]
    ds_read_b64_tr_b16 v[32:33], v12 offset:4096
    ds_read_b64_tr_b16 v[34:35], v12 offset:4608
    v_mfma_f32_32x32x16_bf16 v[80:95], v[40:43], v[28:31], v[80:95]
    ds_read_b64_tr_b16 v[36:37], v13 offset:4096
    ds_read_b64_tr_b16 v[38:39], v13 offset:4608
    v_mfma_f32_32x32x16_bf16 v[96:111], v[44:47], v[28:31], v[96:111]
    s_waitcnt lgkmcnt(0)
    v_mfma_f32_32x32x16_bf16 v[48:63], v[32:35], v[16:19], v[48:63]
    ds_read_b128 v[24:27], v11 offset:0
    ds_read_b128 v[28:31], v11 offset:4096
    v_mfma_f32_32x32x16_bf16 v[64:79], v[36:39], v[16:19], v[64:79]
    ds_read_b64_tr_b16 v[40:41], v12 offset:6144
    ds_read_b64_tr_b16 v[42:43], v12 offset:6656
    v_mfma_f32_32x32x16_bf16 v[80:95], v[32:35], v[20:23], v[80:95]
    ds_read_b64_tr_b16 v[44:45], v13 offset:6144
    ds_read_b64_tr_b16 v[46:47], v13 offset:6656
    v_mfma_f32_32x32x16_bf16 v[96:111], v[36:39], v[20:23], v[96:111]
    s_waitcnt lgkmcnt(0)
    s_barrier
    v_add_u32 v8, 0xc000, v8
    v_add_u32 v9, 0xc000, v9
    v_add_u32 v10, 0xc000, v10
    v_add_u32 v11, 0xc000, v11
    v_add_u32 v12, 0xc000, v12
    v_add_u32 v13, 0xc000, v13
    v_mfma_f32_32x32x16_bf16 v[48:63], v[40:43], v[24:27], v[48:63]
    ds_read_b128 v[16:19], v8 offset:0
    ds_read_b128 v[20:23], v8 offset:4096
    v_mfma_f32_32x32x16_bf16 v[64:79], v[44:47], v[24:27], v[64:79]
    ds_read_b64_tr_b16 v[32:33], v12 offset:0
    ds_read_b64_tr_b16 v[34:35], v12 offset:512
    v_mfma_f32_32x32x16_bf16 v[80:95], v[40:43], v[28:31], v[80:95]
    ds_read_b64_tr_b16 v[36:37], v13 offset:0
    ds_read_b64_tr_b16 v[38:39], v13 offset:512
    v_mfma_f32_32x32x16_bf16 v[96:111], v[44:47], v[28:31], v[96:111]
    v_and_b32 v1, 31, v0
    v_lshlrev_b32 v2, 4, v1
    s_lshl_b32 s58, s44, 7
    s_add_u32 s58, s58, s41
    s_lshl_b32 s59, s58, 4
    s_add_u32 s59, s59, 18874368
    buffer_load_dwordx4 v[120:123], v2, s[24:27], s59 offen offset:0 sc1
    buffer_load_dwordx4 v[124:127], v2, s[24:27], s59 offen offset:512 sc1
    v_lshlrev_b32 v3, 2, v1
    s_lshl_b32 s59, s46, 4
    s_lshl_b32 s60, s59, 2
    s_add_u32 s60, s60, 18915328
    buffer_load_dword v160, v3, s[24:27], s60 offen offset:0 sc1
    buffer_load_dword v161, v3, s[24:27], s60 offen offset:128 sc1
    v_lshlrev_b32 v4, 1, v1
    s_sub_u32 s60, s59, 1536
    s_lshl_b32 s60, s60, 1
    buffer_load_ushort v130, v4, s[28:31], s60 offen offset:0
    buffer_load_ushort v131, v4, s[28:31], s60 offen offset:64
    s_waitcnt lgkmcnt(0)
    v_mfma_f32_32x32x16_bf16 v[48:63], v[32:35], v[16:19], v[48:63]
    ds_read_b128 v[24:27], v9 offset:0
    ds_read_b128 v[28:31], v9 offset:4096
    v_mfma_f32_32x32x16_bf16 v[64:79], v[36:39], v[16:19], v[64:79]
    ds_read_b64_tr_b16 v[40:41], v12 offset:2048
    ds_read_b64_tr_b16 v[42:43], v12 offset:2560
    v_mfma_f32_32x32x16_bf16 v[80:95], v[32:35], v[20:23], v[80:95]
    ds_read_b64_tr_b16 v[44:45], v13 offset:2048
    ds_read_b64_tr_b16 v[46:47], v13 offset:2560
    v_mfma_f32_32x32x16_bf16 v[96:111], v[36:39], v[20:23], v[96:111]
    s_waitcnt lgkmcnt(0)
    v_mfma_f32_32x32x16_bf16 v[48:63], v[40:43], v[24:27], v[48:63]
    ds_read_b128 v[16:19], v10 offset:0
    ds_read_b128 v[20:23], v10 offset:4096
    v_mfma_f32_32x32x16_bf16 v[64:79], v[44:47], v[24:27], v[64:79]
    ds_read_b64_tr_b16 v[32:33], v12 offset:4096
    ds_read_b64_tr_b16 v[34:35], v12 offset:4608
    v_mfma_f32_32x32x16_bf16 v[80:95], v[40:43], v[28:31], v[80:95]
    ds_read_b64_tr_b16 v[36:37], v13 offset:4096
    ds_read_b64_tr_b16 v[38:39], v13 offset:4608
    v_mfma_f32_32x32x16_bf16 v[96:111], v[44:47], v[28:31], v[96:111]
    s_waitcnt lgkmcnt(0)
    v_mfma_f32_32x32x16_bf16 v[48:63], v[32:35], v[16:19], v[48:63]
    ds_read_b128 v[24:27], v11 offset:0
    ds_read_b128 v[28:31], v11 offset:4096
    v_mfma_f32_32x32x16_bf16 v[64:79], v[36:39], v[16:19], v[64:79]
    ds_read_b64_tr_b16 v[40:41], v12 offset:6144
    ds_read_b64_tr_b16 v[42:43], v12 offset:6656
    v_mfma_f32_32x32x16_bf16 v[80:95], v[32:35], v[20:23], v[80:95]
    ds_read_b64_tr_b16 v[44:45], v13 offset:6144
    ds_read_b64_tr_b16 v[46:47], v13 offset:6656
    v_mfma_f32_32x32x16_bf16 v[96:111], v[36:39], v[20:23], v[96:111]
    s_waitcnt lgkmcnt(0)
    v_mfma_f32_32x32x16_bf16 v[48:63], v[40:43], v[24:27], v[48:63]
    v_mfma_f32_32x32x16_bf16 v[64:79], v[44:47], v[24:27], v[64:79]
    v_mfma_f32_32x32x16_bf16 v[80:95], v[40:43], v[28:31], v[80:95]
    v_mfma_f32_32x32x16_bf16 v[96:111], v[44:47], v[28:31], v[96:111]
    s_mov_b32 s60, -1
    s_mov_b32 s61, 0
    s_waitcnt vmcnt(0)
    v_mov_b32 v122, 0
    v_mov_b32 v123, 0
    v_mov_b32 v126, 0
    v_mov_b32 v127, 0
    v_cvt_pk_bf16_f32 v1, v160, v160
    v_lshlrev_b32 v1, 16, v1
    v_sub_f32 v1, v160, v1
    v_cvt_pk_bf16_f32 v1, v160, v1
    v_cndmask_b32 v112, 0, v1, s[60:61]
    v_cndmask_b32 v113, 0, v130, s[60:61]
    v_mov_b32 v114, 0
    v_mov_b32 v115, 0
    v_cvt_pk_bf16_f32 v1, v161, v161
    v_lshlrev_b32 v1, 16, v1
    v_sub_f32 v1, v161, v1
    v_cvt_pk_bf16_f32 v1, v161, v1
    v_cndmask_b32 v116, 0, v1, s[60:61]
    v_cndmask_b32 v117, 0, v131, s[60:61]
    v_mov_b32 v118, 0
    v_mov_b32 v119, 0
    s_nop 1
    v_mfma_f32_32x32x16_bf16 v[48:63], v[112:115], v[120:123], v[48:63]
    v_mfma_f32_32x32x16_bf16 v[64:79], v[116:119], v[120:123], v[64:79]
    v_mfma_f32_32x32x16_bf16 v[80:95], v[112:115], v[124:127], v[80:95]
    v_mfma_f32_32x32x16_bf16 v[96:111], v[116:119], v[124:127], v[96:111]
    v_lshlrev_b32 v7, 4, v0
    s_lshl_b32 s58, s44, 2
    s_lshr_b32 s59, s41, 5
    s_add_u32 s58, s58, s59
    s_mov_b32 s59, s46
    s_nop 4
    s_add_u32 s62, s58, 0
    s_mul_i32 s62, s62, 147456
    s_add_u32 s63, s59, -64
    s_lshl_b32 s63, s63, 10
    s_add_u32 s62, s62, s63
    s_add_u32 s62, s62, 8388608
    v_mul_f32 v48, v48, |v48|
    v_mul_f32 v49, v49, |v49|
    v_mul_f32 v50, v50, |v50|
    v_mul_f32 v51, v51, |v51|
    v_mul_f32 v52, v52, |v52|
    v_mul_f32 v53, v53, |v53|
    v_mul_f32 v54, v54, |v54|
    v_mul_f32 v55, v55, |v55|
    v_cvt_pk_bf16_f32 v16, v48, v49
    v_cvt_pk_bf16_f32 v17, v50, v51
    v_cvt_pk_bf16_f32 v18, v52, v53
    v_cvt_pk_bf16_f32 v19, v54, v55
    v_pk_max_i16 v16, v16, 0
    v_pk_max_i16 v17, v17, 0
    v_pk_max_i16 v18, v18, 0
    v_pk_max_i16 v19, v19, 0
    buffer_store_dwordx4 v[16:19], v7, s[24:27], s62 offen offset:0 sc1
    v_mul_f32 v56, v56, |v56|
    v_mul_f32 v57, v57, |v57|
    v_mul_f32 v58, v58, |v58|
    v_mul_f32 v59, v59, |v59|
    v_mul_f32 v60, v60, |v60|
    v_mul_f32 v61, v61, |v61|
    v_mul_f32 v62, v62, |v62|
    v_mul_f32 v63, v63, |v63|
    v_cvt_pk_bf16_f32 v20, v56, v57
    v_cvt_pk_bf16_f32 v21, v58, v59
    v_cvt_pk_bf16_f32 v22, v60, v61
    v_cvt_pk_bf16_f32 v23, v62, v63
    v_pk_max_i16 v20, v20, 0
    v_pk_max_i16 v21, v21, 0
    v_pk_max_i16 v22, v22, 0
    v_pk_max_i16 v23, v23, 0
    buffer_store_dwordx4 v[20:23], v7, s[24:27], s62 offen offset:1024 sc1
    s_add_u32 s62, s58, 0
    s_mul_i32 s62, s62, 147456
    s_add_u32 s63, s59, -62
    s_lshl_b32 s63, s63, 10
    s_add_u32 s62, s62, s63
    s_add_u32 s62, s62, 8388608
    v_mul_f32 v64, v64, |v64|
    v_mul_f32 v65, v65, |v65|
    v_mul_f32 v66, v66, |v66|
    v_mul_f32 v67, v67, |v67|
    v_mul_f32 v68, v68, |v68|
    v_mul_f32 v69, v69, |v69|
    v_mul_f32 v70, v70, |v70|
    v_mul_f32 v71, v71, |v71|
    v_cvt_pk_bf16_f32 v32, v64, v65
    v_cvt_pk_bf16_f32 v33, v66, v67
    v_cvt_pk_bf16_f32 v34, v68, v69
    v_cvt_pk_bf16_f32 v35, v70, v71
    v_pk_max_i16 v32, v32, 0
    v_pk_max_i16 v33, v33, 0
    v_pk_max_i16 v34, v34, 0
    v_pk_max_i16 v35, v35, 0
    buffer_store_dwordx4 v[32:35], v7, s[24:27], s62 offen offset:0 sc1
    v_mul_f32 v72, v72, |v72|
    v_mul_f32 v73, v73, |v73|
    v_mul_f32 v74, v74, |v74|
    v_mul_f32 v75, v75, |v75|
    v_mul_f32 v76, v76, |v76|
    v_mul_f32 v77, v77, |v77|
    v_mul_f32 v78, v78, |v78|
    v_mul_f32 v79, v79, |v79|
    v_cvt_pk_bf16_f32 v36, v72, v73
    v_cvt_pk_bf16_f32 v37, v74, v75
    v_cvt_pk_bf16_f32 v38, v76, v77
    v_cvt_pk_bf16_f32 v39, v78, v79
    v_pk_max_i16 v36, v36, 0
    v_pk_max_i16 v37, v37, 0
    v_pk_max_i16 v38, v38, 0
    v_pk_max_i16 v39, v39, 0
    buffer_store_dwordx4 v[36:39], v7, s[24:27], s62 offen offset:1024 sc1
    s_add_u32 s62, s58, 1
    s_mul_i32 s62, s62, 147456
    s_add_u32 s63, s59, -64
    s_lshl_b32 s63, s63, 10
    s_add_u32 s62, s62, s63
    s_add_u32 s62, s62, 8388608
    v_mul_f32 v80, v80, |v80|
    v_mul_f32 v81, v81, |v81|
    v_mul_f32 v82, v82, |v82|
    v_mul_f32 v83, v83, |v83|
    v_mul_f32 v84, v84, |v84|
    v_mul_f32 v85, v85, |v85|
    v_mul_f32 v86, v86, |v86|
    v_mul_f32 v87, v87, |v87|
    v_cvt_pk_bf16_f32 v16, v80, v81
    v_cvt_pk_bf16_f32 v17, v82, v83
    v_cvt_pk_bf16_f32 v18, v84, v85
    v_cvt_pk_bf16_f32 v19, v86, v87
    v_pk_max_i16 v16, v16, 0
    v_pk_max_i16 v17, v17, 0
    v_pk_max_i16 v18, v18, 0
    v_pk_max_i16 v19, v19, 0
    buffer_store_dwordx4 v[16:19], v7, s[24:27], s62 offen offset:0 sc1
    v_mul_f32 v88, v88, |v88|
    v_mul_f32 v89, v89, |v89|
    v_mul_f32 v90, v90, |v90|
    v_mul_f32 v91, v91, |v91|
    v_mul_f32 v92, v92, |v92|
    v_mul_f32 v93, v93, |v93|
    v_mul_f32 v94, v94, |v94|
    v_mul_f32 v95, v95, |v95|
    v_cvt_pk_bf16_f32 v20, v88, v89
    v_cvt_pk_bf16_f32 v21, v90, v91
    v_cvt_pk_bf16_f32 v22, v92, v93
    v_cvt_pk_bf16_f32 v23, v94, v95
    v_pk_max_i16 v20, v20, 0
    v_pk_max_i16 v21, v21, 0
    v_pk_max_i16 v22, v22, 0
    v_pk_max_i16 v23, v23, 0
    buffer_store_dwordx4 v[20:23], v7, s[24:27], s62 offen offset:1024 sc1
    s_add_u32 s62, s58, 1
    s_mul_i32 s62, s62, 147456
    s_add_u32 s63, s59, -62
    s_lshl_b32 s63, s63, 10
    s_add_u32 s62, s62, s63
    s_add_u32 s62, s62, 8388608
    v_mul_f32 v96, v96, |v96|
    v_mul_f32 v97, v97, |v97|
    v_mul_f32 v98, v98, |v98|
    v_mul_f32 v99, v99, |v99|
    v_mul_f32 v100, v100, |v100|
    v_mul_f32 v101, v101, |v101|
    v_mul_f32 v102, v102, |v102|
    v_mul_f32 v103, v103, |v103|
    v_cvt_pk_bf16_f32 v32, v96, v97
    v_cvt_pk_bf16_f32 v33, v98, v99
    v_cvt_pk_bf16_f32 v34, v100, v101
    v_cvt_pk_bf16_f32 v35, v102, v103
    v_pk_max_i16 v32, v32, 0
    v_pk_max_i16 v33, v33, 0
    v_pk_max_i16 v34, v34, 0
    v_pk_max_i16 v35, v35, 0
    buffer_store_dwordx4 v[32:35], v7, s[24:27], s62 offen offset:0 sc1
    v_mul_f32 v104, v104, |v104|
    v_mul_f32 v105, v105, |v105|
    v_mul_f32 v106, v106, |v106|
    v_mul_f32 v107, v107, |v107|
    v_mul_f32 v108, v108, |v108|
    v_mul_f32 v109, v109, |v109|
    v_mul_f32 v110, v110, |v110|
    v_mul_f32 v111, v111, |v111|
    v_cvt_pk_bf16_f32 v36, v104, v105
    v_cvt_pk_bf16_f32 v37, v106, v107
    v_cvt_pk_bf16_f32 v38, v108, v109
    v_cvt_pk_bf16_f32 v39, v110, v111
    v_pk_max_i16 v36, v36, 0
    v_pk_max_i16 v37, v37, 0
    v_pk_max_i16 v38, v38, 0
    v_pk_max_i16 v39, v39, 0
    buffer_store_dwordx4 v[36:39], v7, s[24:27], s62 offen offset:1024 sc1
    s_mov_b32 s97, 7
    s_barrier
    s_branch parallel_p2attn
parallel_QK:
    s_barrier
    ds_read_b128 v[16:19], v8 offset:0
    ds_read_b128 v[20:23], v8 offset:4096
    ds_read_b64_tr_b16 v[32:33], v12 offset:0
    ds_read_b64_tr_b16 v[34:35], v12 offset:512
    ds_read_b64_tr_b16 v[36:37], v13 offset:0
    ds_read_b64_tr_b16 v[38:39], v13 offset:512
    s_waitcnt lgkmcnt(0)
    v_mfma_f32_32x32x16_bf16 v[48:63], v[32:35], v[16:19], v[48:63]
    ds_read_b128 v[24:27], v9 offset:0
    ds_read_b128 v[28:31], v9 offset:4096
    v_mfma_f32_32x32x16_bf16 v[64:79], v[36:39], v[16:19], v[64:79]
    ds_read_b64_tr_b16 v[40:41], v12 offset:2048
    ds_read_b64_tr_b16 v[42:43], v12 offset:2560
    v_mfma_f32_32x32x16_bf16 v[80:95], v[32:35], v[20:23], v[80:95]
    ds_read_b64_tr_b16 v[44:45], v13 offset:2048
    ds_read_b64_tr_b16 v[46:47], v13 offset:2560
    v_mfma_f32_32x32x16_bf16 v[96:111], v[36:39], v[20:23], v[96:111]
    s_waitcnt lgkmcnt(0)
    v_mfma_f32_32x32x16_bf16 v[48:63], v[40:43], v[24:27], v[48:63]
    ds_read_b128 v[16:19], v10 offset:0
    ds_read_b128 v[20:23], v10 offset:4096
    v_mfma_f32_32x32x16_bf16 v[64:79], v[44:47], v[24:27], v[64:79]
    ds_read_b64_tr_b16 v[32:33], v12 offset:4096
    ds_read_b64_tr_b16 v[34:35], v12 offset:4608
    v_mfma_f32_32x32x16_bf16 v[80:95], v[40:43], v[28:31], v[80:95]
    ds_read_b64_tr_b16 v[36:37], v13 offset:4096
    ds_read_b64_tr_b16 v[38:39], v13 offset:4608
    v_mfma_f32_32x32x16_bf16 v[96:111], v[44:47], v[28:31], v[96:111]
    s_waitcnt lgkmcnt(0)
    v_mfma_f32_32x32x16_bf16 v[48:63], v[32:35], v[16:19], v[48:63]
    ds_read_b128 v[24:27], v11 offset:0
    ds_read_b128 v[28:31], v11 offset:4096
    v_mfma_f32_32x32x16_bf16 v[64:79], v[36:39], v[16:19], v[64:79]
    ds_read_b64_tr_b16 v[40:41], v12 offset:6144
    ds_read_b64_tr_b16 v[42:43], v12 offset:6656
    v_mfma_f32_32x32x16_bf16 v[80:95], v[32:35], v[20:23], v[80:95]
    ds_read_b64_tr_b16 v[44:45], v13 offset:6144
    ds_read_b64_tr_b16 v[46:47], v13 offset:6656
    v_mfma_f32_32x32x16_bf16 v[96:111], v[36:39], v[20:23], v[96:111]
    s_waitcnt lgkmcnt(0)
    s_barrier
    v_add_u32 v8, 0xc000, v8
    v_add_u32 v9, 0xc000, v9
    v_add_u32 v10, 0xc000, v10
    v_add_u32 v11, 0xc000, v11
    v_add_u32 v12, 0xc000, v12
    v_add_u32 v13, 0xc000, v13
    v_mfma_f32_32x32x16_bf16 v[48:63], v[40:43], v[24:27], v[48:63]
    ds_read_b128 v[16:19], v8 offset:0
    ds_read_b128 v[20:23], v8 offset:4096
    v_mfma_f32_32x32x16_bf16 v[64:79], v[44:47], v[24:27], v[64:79]
    ds_read_b64_tr_b16 v[32:33], v12 offset:0
    ds_read_b64_tr_b16 v[34:35], v12 offset:512
    v_mfma_f32_32x32x16_bf16 v[80:95], v[40:43], v[28:31], v[80:95]
    ds_read_b64_tr_b16 v[36:37], v13 offset:0
    ds_read_b64_tr_b16 v[38:39], v13 offset:512
    v_mfma_f32_32x32x16_bf16 v[96:111], v[44:47], v[28:31], v[96:111]
    s_waitcnt lgkmcnt(0)
    v_mfma_f32_32x32x16_bf16 v[48:63], v[32:35], v[16:19], v[48:63]
    ds_read_b128 v[24:27], v9 offset:0
    ds_read_b128 v[28:31], v9 offset:4096
    v_mfma_f32_32x32x16_bf16 v[64:79], v[36:39], v[16:19], v[64:79]
    ds_read_b64_tr_b16 v[40:41], v12 offset:2048
    ds_read_b64_tr_b16 v[42:43], v12 offset:2560
    v_mfma_f32_32x32x16_bf16 v[80:95], v[32:35], v[20:23], v[80:95]
    ds_read_b64_tr_b16 v[44:45], v13 offset:2048
    ds_read_b64_tr_b16 v[46:47], v13 offset:2560
    v_mfma_f32_32x32x16_bf16 v[96:111], v[36:39], v[20:23], v[96:111]
    s_waitcnt lgkmcnt(0)
    v_mfma_f32_32x32x16_bf16 v[48:63], v[40:43], v[24:27], v[48:63]
    ds_read_b128 v[16:19], v10 offset:0
    ds_read_b128 v[20:23], v10 offset:4096
    v_mfma_f32_32x32x16_bf16 v[64:79], v[44:47], v[24:27], v[64:79]
    ds_read_b64_tr_b16 v[32:33], v12 offset:4096
    ds_read_b64_tr_b16 v[34:35], v12 offset:4608
    v_mfma_f32_32x32x16_bf16 v[80:95], v[40:43], v[28:31], v[80:95]
    ds_read_b64_tr_b16 v[36:37], v13 offset:4096
    ds_read_b64_tr_b16 v[38:39], v13 offset:4608
    v_mfma_f32_32x32x16_bf16 v[96:111], v[44:47], v[28:31], v[96:111]
    s_waitcnt lgkmcnt(0)
    v_mfma_f32_32x32x16_bf16 v[48:63], v[32:35], v[16:19], v[48:63]
    ds_read_b128 v[24:27], v11 offset:0
    ds_read_b128 v[28:31], v11 offset:4096
    v_mfma_f32_32x32x16_bf16 v[64:79], v[36:39], v[16:19], v[64:79]
    ds_read_b64_tr_b16 v[40:41], v12 offset:6144
    ds_read_b64_tr_b16 v[42:43], v12 offset:6656
    v_mfma_f32_32x32x16_bf16 v[80:95], v[32:35], v[20:23], v[80:95]
    ds_read_b64_tr_b16 v[44:45], v13 offset:6144
    ds_read_b64_tr_b16 v[46:47], v13 offset:6656
    v_mfma_f32_32x32x16_bf16 v[96:111], v[36:39], v[20:23], v[96:111]
    s_waitcnt lgkmcnt(0)
    s_barrier
    v_add_u32 v8, 0xc000, v8
    v_add_u32 v9, 0xc000, v9
    v_add_u32 v10, 0xc000, v10
    v_add_u32 v11, 0xc000, v11
    v_add_u32 v12, 0xc000, v12
    v_add_u32 v13, 0xc000, v13
    v_mfma_f32_32x32x16_bf16 v[48:63], v[40:43], v[24:27], v[48:63]
    ds_read_b128 v[16:19], v8 offset:0
    ds_read_b128 v[20:23], v8 offset:4096
    v_mfma_f32_32x32x16_bf16 v[64:79], v[44:47], v[24:27], v[64:79]
    ds_read_b64_tr_b16 v[32:33], v12 offset:0
    ds_read_b64_tr_b16 v[34:35], v12 offset:512
    v_mfma_f32_32x32x16_bf16 v[80:95], v[40:43], v[28:31], v[80:95]
    ds_read_b64_tr_b16 v[36:37], v13 offset:0
    ds_read_b64_tr_b16 v[38:39], v13 offset:512
    v_mfma_f32_32x32x16_bf16 v[96:111], v[44:47], v[28:31], v[96:111]
    s_waitcnt lgkmcnt(0)
    v_mfma_f32_32x32x16_bf16 v[48:63], v[32:35], v[16:19], v[48:63]
    ds_read_b128 v[24:27], v9 offset:0
    ds_read_b128 v[28:31], v9 offset:4096
    v_mfma_f32_32x32x16_bf16 v[64:79], v[36:39], v[16:19], v[64:79]
    ds_read_b64_tr_b16 v[40:41], v12 offset:2048
    ds_read_b64_tr_b16 v[42:43], v12 offset:2560
    v_mfma_f32_32x32x16_bf16 v[80:95], v[32:35], v[20:23], v[80:95]
    ds_read_b64_tr_b16 v[44:45], v13 offset:2048
    ds_read_b64_tr_b16 v[46:47], v13 offset:2560
    v_mfma_f32_32x32x16_bf16 v[96:111], v[36:39], v[20:23], v[96:111]
    s_waitcnt lgkmcnt(0)
    v_mfma_f32_32x32x16_bf16 v[48:63], v[40:43], v[24:27], v[48:63]
    ds_read_b128 v[16:19], v10 offset:0
    ds_read_b128 v[20:23], v10 offset:4096
    v_mfma_f32_32x32x16_bf16 v[64:79], v[44:47], v[24:27], v[64:79]
    ds_read_b64_tr_b16 v[32:33], v12 offset:4096
    ds_read_b64_tr_b16 v[34:35], v12 offset:4608
    v_mfma_f32_32x32x16_bf16 v[80:95], v[40:43], v[28:31], v[80:95]
    ds_read_b64_tr_b16 v[36:37], v13 offset:4096
    ds_read_b64_tr_b16 v[38:39], v13 offset:4608
    v_mfma_f32_32x32x16_bf16 v[96:111], v[44:47], v[28:31], v[96:111]
    s_waitcnt lgkmcnt(0)
    v_mfma_f32_32x32x16_bf16 v[48:63], v[32:35], v[16:19], v[48:63]
    ds_read_b128 v[24:27], v11 offset:0
    ds_read_b128 v[28:31], v11 offset:4096
    v_mfma_f32_32x32x16_bf16 v[64:79], v[36:39], v[16:19], v[64:79]
    ds_read_b64_tr_b16 v[40:41], v12 offset:6144
    ds_read_b64_tr_b16 v[42:43], v12 offset:6656
    v_mfma_f32_32x32x16_bf16 v[80:95], v[32:35], v[20:23], v[80:95]
    ds_read_b64_tr_b16 v[44:45], v13 offset:6144
    ds_read_b64_tr_b16 v[46:47], v13 offset:6656
    v_mfma_f32_32x32x16_bf16 v[96:111], v[36:39], v[20:23], v[96:111]
    s_waitcnt lgkmcnt(0)
    s_barrier
    v_add_u32 v8, 0xfffe8000, v8
    v_add_u32 v9, 0xfffe8000, v9
    v_add_u32 v10, 0xfffe8000, v10
    v_add_u32 v11, 0xfffe8000, v11
    v_add_u32 v12, 0xfffe8000, v12
    v_add_u32 v13, 0xfffe8000, v13
    v_mfma_f32_32x32x16_bf16 v[48:63], v[40:43], v[24:27], v[48:63]
    ds_read_b128 v[16:19], v8 offset:0
    ds_read_b128 v[20:23], v8 offset:4096
    v_mfma_f32_32x32x16_bf16 v[64:79], v[44:47], v[24:27], v[64:79]
    ds_read_b64_tr_b16 v[32:33], v12 offset:0
    ds_read_b64_tr_b16 v[34:35], v12 offset:512
    v_mfma_f32_32x32x16_bf16 v[80:95], v[40:43], v[28:31], v[80:95]
    ds_read_b64_tr_b16 v[36:37], v13 offset:0
    ds_read_b64_tr_b16 v[38:39], v13 offset:512
    v_mfma_f32_32x32x16_bf16 v[96:111], v[44:47], v[28:31], v[96:111]
    s_waitcnt lgkmcnt(0)
    v_mfma_f32_32x32x16_bf16 v[48:63], v[32:35], v[16:19], v[48:63]
    ds_read_b128 v[24:27], v9 offset:0
    ds_read_b128 v[28:31], v9 offset:4096
    v_mfma_f32_32x32x16_bf16 v[64:79], v[36:39], v[16:19], v[64:79]
    ds_read_b64_tr_b16 v[40:41], v12 offset:2048
    ds_read_b64_tr_b16 v[42:43], v12 offset:2560
    v_mfma_f32_32x32x16_bf16 v[80:95], v[32:35], v[20:23], v[80:95]
    ds_read_b64_tr_b16 v[44:45], v13 offset:2048
    ds_read_b64_tr_b16 v[46:47], v13 offset:2560
    v_mfma_f32_32x32x16_bf16 v[96:111], v[36:39], v[20:23], v[96:111]
    s_waitcnt lgkmcnt(0)
    v_mfma_f32_32x32x16_bf16 v[48:63], v[40:43], v[24:27], v[48:63]
    ds_read_b128 v[16:19], v10 offset:0
    ds_read_b128 v[20:23], v10 offset:4096
    v_mfma_f32_32x32x16_bf16 v[64:79], v[44:47], v[24:27], v[64:79]
    ds_read_b64_tr_b16 v[32:33], v12 offset:4096
    ds_read_b64_tr_b16 v[34:35], v12 offset:4608
    v_mfma_f32_32x32x16_bf16 v[80:95], v[40:43], v[28:31], v[80:95]
    ds_read_b64_tr_b16 v[36:37], v13 offset:4096
    ds_read_b64_tr_b16 v[38:39], v13 offset:4608
    v_mfma_f32_32x32x16_bf16 v[96:111], v[44:47], v[28:31], v[96:111]
    s_waitcnt lgkmcnt(0)
    v_mfma_f32_32x32x16_bf16 v[48:63], v[32:35], v[16:19], v[48:63]
    ds_read_b128 v[24:27], v11 offset:0
    ds_read_b128 v[28:31], v11 offset:4096
    v_mfma_f32_32x32x16_bf16 v[64:79], v[36:39], v[16:19], v[64:79]
    ds_read_b64_tr_b16 v[40:41], v12 offset:6144
    ds_read_b64_tr_b16 v[42:43], v12 offset:6656
    v_mfma_f32_32x32x16_bf16 v[80:95], v[32:35], v[20:23], v[80:95]
    ds_read_b64_tr_b16 v[44:45], v13 offset:6144
    ds_read_b64_tr_b16 v[46:47], v13 offset:6656
    v_mfma_f32_32x32x16_bf16 v[96:111], v[36:39], v[20:23], v[96:111]
    s_waitcnt lgkmcnt(0)
    s_barrier
    v_add_u32 v8, 0xc000, v8
    v_add_u32 v9, 0xc000, v9
    v_add_u32 v10, 0xc000, v10
    v_add_u32 v11, 0xc000, v11
    v_add_u32 v12, 0xc000, v12
    v_add_u32 v13, 0xc000, v13
    v_mfma_f32_32x32x16_bf16 v[48:63], v[40:43], v[24:27], v[48:63]
    ds_read_b128 v[16:19], v8 offset:0
    ds_read_b128 v[20:23], v8 offset:4096
    v_mfma_f32_32x32x16_bf16 v[64:79], v[44:47], v[24:27], v[64:79]
    ds_read_b64_tr_b16 v[32:33], v12 offset:0
    ds_read_b64_tr_b16 v[34:35], v12 offset:512
    v_mfma_f32_32x32x16_bf16 v[80:95], v[40:43], v[28:31], v[80:95]
    ds_read_b64_tr_b16 v[36:37], v13 offset:0
    ds_read_b64_tr_b16 v[38:39], v13 offset:512
    v_mfma_f32_32x32x16_bf16 v[96:111], v[44:47], v[28:31], v[96:111]
    s_waitcnt lgkmcnt(0)
    v_mfma_f32_32x32x16_bf16 v[48:63], v[32:35], v[16:19], v[48:63]
    ds_read_b128 v[24:27], v9 offset:0
    ds_read_b128 v[28:31], v9 offset:4096
    v_mfma_f32_32x32x16_bf16 v[64:79], v[36:39], v[16:19], v[64:79]
    ds_read_b64_tr_b16 v[40:41], v12 offset:2048
    ds_read_b64_tr_b16 v[42:43], v12 offset:2560
    v_mfma_f32_32x32x16_bf16 v[80:95], v[32:35], v[20:23], v[80:95]
    ds_read_b64_tr_b16 v[44:45], v13 offset:2048
    ds_read_b64_tr_b16 v[46:47], v13 offset:2560
    v_mfma_f32_32x32x16_bf16 v[96:111], v[36:39], v[20:23], v[96:111]
    s_waitcnt lgkmcnt(0)
    v_mfma_f32_32x32x16_bf16 v[48:63], v[40:43], v[24:27], v[48:63]
    ds_read_b128 v[16:19], v10 offset:0
    ds_read_b128 v[20:23], v10 offset:4096
    v_mfma_f32_32x32x16_bf16 v[64:79], v[44:47], v[24:27], v[64:79]
    ds_read_b64_tr_b16 v[32:33], v12 offset:4096
    ds_read_b64_tr_b16 v[34:35], v12 offset:4608
    v_mfma_f32_32x32x16_bf16 v[80:95], v[40:43], v[28:31], v[80:95]
    ds_read_b64_tr_b16 v[36:37], v13 offset:4096
    ds_read_b64_tr_b16 v[38:39], v13 offset:4608
    v_mfma_f32_32x32x16_bf16 v[96:111], v[44:47], v[28:31], v[96:111]
    s_waitcnt lgkmcnt(0)
    v_mfma_f32_32x32x16_bf16 v[48:63], v[32:35], v[16:19], v[48:63]
    ds_read_b128 v[24:27], v11 offset:0
    ds_read_b128 v[28:31], v11 offset:4096
    v_mfma_f32_32x32x16_bf16 v[64:79], v[36:39], v[16:19], v[64:79]
    ds_read_b64_tr_b16 v[40:41], v12 offset:6144
    ds_read_b64_tr_b16 v[42:43], v12 offset:6656
    v_mfma_f32_32x32x16_bf16 v[80:95], v[32:35], v[20:23], v[80:95]
    ds_read_b64_tr_b16 v[44:45], v13 offset:6144
    ds_read_b64_tr_b16 v[46:47], v13 offset:6656
    v_mfma_f32_32x32x16_bf16 v[96:111], v[36:39], v[20:23], v[96:111]
    s_waitcnt lgkmcnt(0)
    s_barrier
    v_add_u32 v8, 0xc000, v8
    v_add_u32 v9, 0xc000, v9
    v_add_u32 v10, 0xc000, v10
    v_add_u32 v11, 0xc000, v11
    v_add_u32 v12, 0xc000, v12
    v_add_u32 v13, 0xc000, v13
    v_mfma_f32_32x32x16_bf16 v[48:63], v[40:43], v[24:27], v[48:63]
    ds_read_b128 v[16:19], v8 offset:0
    ds_read_b128 v[20:23], v8 offset:4096
    v_mfma_f32_32x32x16_bf16 v[64:79], v[44:47], v[24:27], v[64:79]
    ds_read_b64_tr_b16 v[32:33], v12 offset:0
    ds_read_b64_tr_b16 v[34:35], v12 offset:512
    v_mfma_f32_32x32x16_bf16 v[80:95], v[40:43], v[28:31], v[80:95]
    ds_read_b64_tr_b16 v[36:37], v13 offset:0
    ds_read_b64_tr_b16 v[38:39], v13 offset:512
    v_mfma_f32_32x32x16_bf16 v[96:111], v[44:47], v[28:31], v[96:111]
    s_waitcnt lgkmcnt(0)
    v_mfma_f32_32x32x16_bf16 v[48:63], v[32:35], v[16:19], v[48:63]
    ds_read_b128 v[24:27], v9 offset:0
    ds_read_b128 v[28:31], v9 offset:4096
    v_mfma_f32_32x32x16_bf16 v[64:79], v[36:39], v[16:19], v[64:79]
    ds_read_b64_tr_b16 v[40:41], v12 offset:2048
    ds_read_b64_tr_b16 v[42:43], v12 offset:2560
    v_mfma_f32_32x32x16_bf16 v[80:95], v[32:35], v[20:23], v[80:95]
    ds_read_b64_tr_b16 v[44:45], v13 offset:2048
    ds_read_b64_tr_b16 v[46:47], v13 offset:2560
    v_mfma_f32_32x32x16_bf16 v[96:111], v[36:39], v[20:23], v[96:111]
    s_waitcnt lgkmcnt(0)
    v_mfma_f32_32x32x16_bf16 v[48:63], v[40:43], v[24:27], v[48:63]
    ds_read_b128 v[16:19], v10 offset:0
    ds_read_b128 v[20:23], v10 offset:4096
    v_mfma_f32_32x32x16_bf16 v[64:79], v[44:47], v[24:27], v[64:79]
    ds_read_b64_tr_b16 v[32:33], v12 offset:4096
    ds_read_b64_tr_b16 v[34:35], v12 offset:4608
    v_mfma_f32_32x32x16_bf16 v[80:95], v[40:43], v[28:31], v[80:95]
    ds_read_b64_tr_b16 v[36:37], v13 offset:4096
    ds_read_b64_tr_b16 v[38:39], v13 offset:4608
    v_mfma_f32_32x32x16_bf16 v[96:111], v[44:47], v[28:31], v[96:111]
    s_waitcnt lgkmcnt(0)
    v_mfma_f32_32x32x16_bf16 v[48:63], v[32:35], v[16:19], v[48:63]
    ds_read_b128 v[24:27], v11 offset:0
    ds_read_b128 v[28:31], v11 offset:4096
    v_mfma_f32_32x32x16_bf16 v[64:79], v[36:39], v[16:19], v[64:79]
    ds_read_b64_tr_b16 v[40:41], v12 offset:6144
    ds_read_b64_tr_b16 v[42:43], v12 offset:6656
    v_mfma_f32_32x32x16_bf16 v[80:95], v[32:35], v[20:23], v[80:95]
    ds_read_b64_tr_b16 v[44:45], v13 offset:6144
    ds_read_b64_tr_b16 v[46:47], v13 offset:6656
    v_mfma_f32_32x32x16_bf16 v[96:111], v[36:39], v[20:23], v[96:111]
    s_waitcnt lgkmcnt(0)
    s_barrier
    v_add_u32 v8, 0xfffe8000, v8
    v_add_u32 v9, 0xfffe8000, v9
    v_add_u32 v10, 0xfffe8000, v10
    v_add_u32 v11, 0xfffe8000, v11
    v_add_u32 v12, 0xfffe8000, v12
    v_add_u32 v13, 0xfffe8000, v13
    v_mfma_f32_32x32x16_bf16 v[48:63], v[40:43], v[24:27], v[48:63]
    ds_read_b128 v[16:19], v8 offset:0
    ds_read_b128 v[20:23], v8 offset:4096
    v_mfma_f32_32x32x16_bf16 v[64:79], v[44:47], v[24:27], v[64:79]
    ds_read_b64_tr_b16 v[32:33], v12 offset:0
    ds_read_b64_tr_b16 v[34:35], v12 offset:512
    v_mfma_f32_32x32x16_bf16 v[80:95], v[40:43], v[28:31], v[80:95]
    ds_read_b64_tr_b16 v[36:37], v13 offset:0
    ds_read_b64_tr_b16 v[38:39], v13 offset:512
    v_mfma_f32_32x32x16_bf16 v[96:111], v[44:47], v[28:31], v[96:111]
    s_waitcnt lgkmcnt(0)
    v_mfma_f32_32x32x16_bf16 v[48:63], v[32:35], v[16:19], v[48:63]
    ds_read_b128 v[24:27], v9 offset:0
    ds_read_b128 v[28:31], v9 offset:4096
    v_mfma_f32_32x32x16_bf16 v[64:79], v[36:39], v[16:19], v[64:79]
    ds_read_b64_tr_b16 v[40:41], v12 offset:2048
    ds_read_b64_tr_b16 v[42:43], v12 offset:2560
    v_mfma_f32_32x32x16_bf16 v[80:95], v[32:35], v[20:23], v[80:95]
    ds_read_b64_tr_b16 v[44:45], v13 offset:2048
    ds_read_b64_tr_b16 v[46:47], v13 offset:2560
    v_mfma_f32_32x32x16_bf16 v[96:111], v[36:39], v[20:23], v[96:111]
    s_waitcnt lgkmcnt(0)
    v_mfma_f32_32x32x16_bf16 v[48:63], v[40:43], v[24:27], v[48:63]
    ds_read_b128 v[16:19], v10 offset:0
    ds_read_b128 v[20:23], v10 offset:4096
    v_mfma_f32_32x32x16_bf16 v[64:79], v[44:47], v[24:27], v[64:79]
    ds_read_b64_tr_b16 v[32:33], v12 offset:4096
    ds_read_b64_tr_b16 v[34:35], v12 offset:4608
    v_mfma_f32_32x32x16_bf16 v[80:95], v[40:43], v[28:31], v[80:95]
    ds_read_b64_tr_b16 v[36:37], v13 offset:4096
    ds_read_b64_tr_b16 v[38:39], v13 offset:4608
    v_mfma_f32_32x32x16_bf16 v[96:111], v[44:47], v[28:31], v[96:111]
    s_waitcnt lgkmcnt(0)
    v_mfma_f32_32x32x16_bf16 v[48:63], v[32:35], v[16:19], v[48:63]
    ds_read_b128 v[24:27], v11 offset:0
    ds_read_b128 v[28:31], v11 offset:4096
    v_mfma_f32_32x32x16_bf16 v[64:79], v[36:39], v[16:19], v[64:79]
    ds_read_b64_tr_b16 v[40:41], v12 offset:6144
    ds_read_b64_tr_b16 v[42:43], v12 offset:6656
    v_mfma_f32_32x32x16_bf16 v[80:95], v[32:35], v[20:23], v[80:95]
    ds_read_b64_tr_b16 v[44:45], v13 offset:6144
    ds_read_b64_tr_b16 v[46:47], v13 offset:6656
    v_mfma_f32_32x32x16_bf16 v[96:111], v[36:39], v[20:23], v[96:111]
    s_waitcnt lgkmcnt(0)
    s_barrier
    v_add_u32 v8, 0xc000, v8
    v_add_u32 v9, 0xc000, v9
    v_add_u32 v10, 0xc000, v10
    v_add_u32 v11, 0xc000, v11
    v_add_u32 v12, 0xc000, v12
    v_add_u32 v13, 0xc000, v13
    v_mfma_f32_32x32x16_bf16 v[48:63], v[40:43], v[24:27], v[48:63]
    ds_read_b128 v[16:19], v8 offset:0
    ds_read_b128 v[20:23], v8 offset:4096
    v_mfma_f32_32x32x16_bf16 v[64:79], v[44:47], v[24:27], v[64:79]
    ds_read_b64_tr_b16 v[32:33], v12 offset:0
    ds_read_b64_tr_b16 v[34:35], v12 offset:512
    v_mfma_f32_32x32x16_bf16 v[80:95], v[40:43], v[28:31], v[80:95]
    ds_read_b64_tr_b16 v[36:37], v13 offset:0
    ds_read_b64_tr_b16 v[38:39], v13 offset:512
    v_mfma_f32_32x32x16_bf16 v[96:111], v[44:47], v[28:31], v[96:111]
    v_and_b32 v1, 31, v0
    v_lshlrev_b32 v2, 4, v1
    s_lshl_b32 s58, s44, 7
    s_add_u32 s58, s58, s41
    s_lshl_b32 s59, s58, 4
    s_add_u32 s59, s59, 18874368
    buffer_load_dwordx4 v[120:123], v2, s[24:27], s59 offen offset:0 sc1
    buffer_load_dwordx4 v[124:127], v2, s[24:27], s59 offen offset:512 sc1
    v_lshlrev_b32 v3, 2, v1
    s_lshl_b32 s59, s46, 4
    s_lshl_b32 s60, s59, 2
    s_add_u32 s60, s60, 18915328
    buffer_load_dword v160, v3, s[24:27], s60 offen offset:0 sc1
    buffer_load_dword v161, v3, s[24:27], s60 offen offset:128 sc1
    s_waitcnt lgkmcnt(0)
    v_mfma_f32_32x32x16_bf16 v[48:63], v[32:35], v[16:19], v[48:63]
    ds_read_b128 v[24:27], v9 offset:0
    ds_read_b128 v[28:31], v9 offset:4096
    v_mfma_f32_32x32x16_bf16 v[64:79], v[36:39], v[16:19], v[64:79]
    ds_read_b64_tr_b16 v[40:41], v12 offset:2048
    ds_read_b64_tr_b16 v[42:43], v12 offset:2560
    v_mfma_f32_32x32x16_bf16 v[80:95], v[32:35], v[20:23], v[80:95]
    ds_read_b64_tr_b16 v[44:45], v13 offset:2048
    ds_read_b64_tr_b16 v[46:47], v13 offset:2560
    v_mfma_f32_32x32x16_bf16 v[96:111], v[36:39], v[20:23], v[96:111]
    s_waitcnt lgkmcnt(0)
    v_mfma_f32_32x32x16_bf16 v[48:63], v[40:43], v[24:27], v[48:63]
    ds_read_b128 v[16:19], v10 offset:0
    ds_read_b128 v[20:23], v10 offset:4096
    v_mfma_f32_32x32x16_bf16 v[64:79], v[44:47], v[24:27], v[64:79]
    ds_read_b64_tr_b16 v[32:33], v12 offset:4096
    ds_read_b64_tr_b16 v[34:35], v12 offset:4608
    v_mfma_f32_32x32x16_bf16 v[80:95], v[40:43], v[28:31], v[80:95]
    ds_read_b64_tr_b16 v[36:37], v13 offset:4096
    ds_read_b64_tr_b16 v[38:39], v13 offset:4608
    v_mfma_f32_32x32x16_bf16 v[96:111], v[44:47], v[28:31], v[96:111]
    s_waitcnt lgkmcnt(0)
    v_mfma_f32_32x32x16_bf16 v[48:63], v[32:35], v[16:19], v[48:63]
    ds_read_b128 v[24:27], v11 offset:0
    ds_read_b128 v[28:31], v11 offset:4096
    v_mfma_f32_32x32x16_bf16 v[64:79], v[36:39], v[16:19], v[64:79]
    ds_read_b64_tr_b16 v[40:41], v12 offset:6144
    ds_read_b64_tr_b16 v[42:43], v12 offset:6656
    v_mfma_f32_32x32x16_bf16 v[80:95], v[32:35], v[20:23], v[80:95]
    ds_read_b64_tr_b16 v[44:45], v13 offset:6144
    ds_read_b64_tr_b16 v[46:47], v13 offset:6656
    v_mfma_f32_32x32x16_bf16 v[96:111], v[36:39], v[20:23], v[96:111]
    s_waitcnt lgkmcnt(0)
    v_mfma_f32_32x32x16_bf16 v[48:63], v[40:43], v[24:27], v[48:63]
    v_mfma_f32_32x32x16_bf16 v[64:79], v[44:47], v[24:27], v[64:79]
    v_mfma_f32_32x32x16_bf16 v[80:95], v[40:43], v[28:31], v[80:95]
    v_mfma_f32_32x32x16_bf16 v[96:111], v[44:47], v[28:31], v[96:111]
    s_mov_b32 s60, -1
    s_mov_b32 s61, 0
    s_waitcnt vmcnt(0)
    v_mov_b32 v128, v122
    v_mov_b32 v122, 0
    v_mov_b32 v123, 0
    v_mov_b32 v129, v126
    v_mov_b32 v126, 0
    v_mov_b32 v127, 0
    v_cvt_pk_bf16_f32 v1, v160, v160
    v_lshlrev_b32 v1, 16, v1
    v_sub_f32 v1, v160, v1
    v_cvt_pk_bf16_f32 v1, v160, v1
    v_cndmask_b32 v112, 0, v1, s[60:61]
    v_mov_b32 v113, 0
    v_mov_b32 v114, 0
    v_mov_b32 v115, 0
    v_cvt_pk_bf16_f32 v1, v161, v161
    v_lshlrev_b32 v1, 16, v1
    v_sub_f32 v1, v161, v1
    v_cvt_pk_bf16_f32 v1, v161, v1
    v_cndmask_b32 v116, 0, v1, s[60:61]
    v_mov_b32 v117, 0
    v_mov_b32 v118, 0
    v_mov_b32 v119, 0
    s_nop 1
    v_mfma_f32_32x32x16_bf16 v[48:63], v[112:115], v[120:123], v[48:63]
    v_mfma_f32_32x32x16_bf16 v[64:79], v[116:119], v[120:123], v[64:79]
    v_mfma_f32_32x32x16_bf16 v[80:95], v[112:115], v[124:127], v[80:95]
    v_mfma_f32_32x32x16_bf16 v[96:111], v[116:119], v[124:127], v[96:111]
    v_lshlrev_b32 v7, 4, v0
    s_lshl_b32 s58, s44, 2
    s_lshr_b32 s59, s41, 5
    s_add_u32 s58, s58, s59
    s_mov_b32 s59, s46
    s_cmp_lt_u32 s46, 32
    s_cselect_b32 s63, 0x3eb8aa3b, 1.0
    v_mul_f32 v128, s63, v128
    v_mul_f32 v129, s63, v129
    s_nop 4
    v_mul_f32 v48, v48, v128
    v_mul_f32 v49, v49, v128
    v_mul_f32 v50, v50, v128
    v_mul_f32 v51, v51, v128
    v_mul_f32 v52, v52, v128
    v_mul_f32 v53, v53, v128
    v_mul_f32 v54, v54, v128
    v_mul_f32 v55, v55, v128
    v_cvt_pk_bf16_f32 v16, v48, v49
    v_cvt_pk_bf16_f32 v17, v50, v51
    v_cvt_pk_bf16_f32 v18, v52, v53
    v_cvt_pk_bf16_f32 v19, v54, v55
    s_add_u32 s62, s59, 0
    s_lshl_b32 s62, s62, 16
    s_add_u32 s63, s58, 0
    s_lshl_b32 s63, s63, 10
    s_add_u32 s62, s62, s63
    buffer_store_dwordx4 v[16:19], v7, s[24:27], s62 offen sc1
    v_mul_f32 v56, v56, v128
    v_mul_f32 v57, v57, v128
    v_mul_f32 v58, v58, v128
    v_mul_f32 v59, v59, v128
    v_mul_f32 v60, v60, v128
    v_mul_f32 v61, v61, v128
    v_mul_f32 v62, v62, v128
    v_mul_f32 v63, v63, v128
    v_cvt_pk_bf16_f32 v20, v56, v57
    v_cvt_pk_bf16_f32 v21, v58, v59
    v_cvt_pk_bf16_f32 v22, v60, v61
    v_cvt_pk_bf16_f32 v23, v62, v63
    s_add_u32 s62, s59, 1
    s_lshl_b32 s62, s62, 16
    s_add_u32 s63, s58, 0
    s_lshl_b32 s63, s63, 10
    s_add_u32 s62, s62, s63
    buffer_store_dwordx4 v[20:23], v7, s[24:27], s62 offen sc1
    v_mul_f32 v64, v64, v128
    v_mul_f32 v65, v65, v128
    v_mul_f32 v66, v66, v128
    v_mul_f32 v67, v67, v128
    v_mul_f32 v68, v68, v128
    v_mul_f32 v69, v69, v128
    v_mul_f32 v70, v70, v128
    v_mul_f32 v71, v71, v128
    v_cvt_pk_bf16_f32 v32, v64, v65
    v_cvt_pk_bf16_f32 v33, v66, v67
    v_cvt_pk_bf16_f32 v34, v68, v69
    v_cvt_pk_bf16_f32 v35, v70, v71
    s_add_u32 s62, s59, 2
    s_lshl_b32 s62, s62, 16
    s_add_u32 s63, s58, 0
    s_lshl_b32 s63, s63, 10
    s_add_u32 s62, s62, s63
    buffer_store_dwordx4 v[32:35], v7, s[24:27], s62 offen sc1
    v_mul_f32 v72, v72, v128
    v_mul_f32 v73, v73, v128
    v_mul_f32 v74, v74, v128
    v_mul_f32 v75, v75, v128
    v_mul_f32 v76, v76, v128
    v_mul_f32 v77, v77, v128
    v_mul_f32 v78, v78, v128
    v_mul_f32 v79, v79, v128
    v_cvt_pk_bf16_f32 v36, v72, v73
    v_cvt_pk_bf16_f32 v37, v74, v75
    v_cvt_pk_bf16_f32 v38, v76, v77
    v_cvt_pk_bf16_f32 v39, v78, v79
    s_add_u32 s62, s59, 3
    s_lshl_b32 s62, s62, 16
    s_add_u32 s63, s58, 0
    s_lshl_b32 s63, s63, 10
    s_add_u32 s62, s62, s63
    buffer_store_dwordx4 v[36:39], v7, s[24:27], s62 offen sc1
    v_mul_f32 v80, v80, v129
    v_mul_f32 v81, v81, v129
    v_mul_f32 v82, v82, v129
    v_mul_f32 v83, v83, v129
    v_mul_f32 v84, v84, v129
    v_mul_f32 v85, v85, v129
    v_mul_f32 v86, v86, v129
    v_mul_f32 v87, v87, v129
    v_cvt_pk_bf16_f32 v16, v80, v81
    v_cvt_pk_bf16_f32 v17, v82, v83
    v_cvt_pk_bf16_f32 v18, v84, v85
    v_cvt_pk_bf16_f32 v19, v86, v87
    s_add_u32 s62, s59, 0
    s_lshl_b32 s62, s62, 16
    s_add_u32 s63, s58, 1
    s_lshl_b32 s63, s63, 10
    s_add_u32 s62, s62, s63
    buffer_store_dwordx4 v[16:19], v7, s[24:27], s62 offen sc1
    v_mul_f32 v88, v88, v129
    v_mul_f32 v89, v89, v129
    v_mul_f32 v90, v90, v129
    v_mul_f32 v91, v91, v129
    v_mul_f32 v92, v92, v129
    v_mul_f32 v93, v93, v129
    v_mul_f32 v94, v94, v129
    v_mul_f32 v95, v95, v129
    v_cvt_pk_bf16_f32 v20, v88, v89
    v_cvt_pk_bf16_f32 v21, v90, v91
    v_cvt_pk_bf16_f32 v22, v92, v93
    v_cvt_pk_bf16_f32 v23, v94, v95
    s_add_u32 s62, s59, 1
    s_lshl_b32 s62, s62, 16
    s_add_u32 s63, s58, 1
    s_lshl_b32 s63, s63, 10
    s_add_u32 s62, s62, s63
    buffer_store_dwordx4 v[20:23], v7, s[24:27], s62 offen sc1
    v_mul_f32 v96, v96, v129
    v_mul_f32 v97, v97, v129
    v_mul_f32 v98, v98, v129
    v_mul_f32 v99, v99, v129
    v_mul_f32 v100, v100, v129
    v_mul_f32 v101, v101, v129
    v_mul_f32 v102, v102, v129
    v_mul_f32 v103, v103, v129
    v_cvt_pk_bf16_f32 v32, v96, v97
    v_cvt_pk_bf16_f32 v33, v98, v99
    v_cvt_pk_bf16_f32 v34, v100, v101
    v_cvt_pk_bf16_f32 v35, v102, v103
    s_add_u32 s62, s59, 2
    s_lshl_b32 s62, s62, 16
    s_add_u32 s63, s58, 1
    s_lshl_b32 s63, s63, 10
    s_add_u32 s62, s62, s63
    buffer_store_dwordx4 v[32:35], v7, s[24:27], s62 offen sc1
    v_mul_f32 v104, v104, v129
    v_mul_f32 v105, v105, v129
    v_mul_f32 v106, v106, v129
    v_mul_f32 v107, v107, v129
    v_mul_f32 v108, v108, v129
    v_mul_f32 v109, v109, v129
    v_mul_f32 v110, v110, v129
    v_mul_f32 v111, v111, v129
    v_cvt_pk_bf16_f32 v36, v104, v105
    v_cvt_pk_bf16_f32 v37, v106, v107
    v_cvt_pk_bf16_f32 v38, v108, v109
    v_cvt_pk_bf16_f32 v39, v110, v111
    s_add_u32 s62, s59, 3
    s_lshl_b32 s62, s62, 16
    s_add_u32 s63, s58, 1
    s_lshl_b32 s63, s63, 10
    s_add_u32 s62, s62, s63
    buffer_store_dwordx4 v[36:39], v7, s[24:27], s62 offen sc1
    s_waitcnt vmcnt(0)
    s_barrier
    s_branch parallel_p2attn
parallel_V:
    s_barrier
    ds_read_b128 v[16:19], v8 offset:0
    ds_read_b128 v[20:23], v8 offset:4096
    ds_read_b64_tr_b16 v[32:33], v12 offset:0
    ds_read_b64_tr_b16 v[34:35], v12 offset:512
    ds_read_b64_tr_b16 v[36:37], v13 offset:0
    ds_read_b64_tr_b16 v[38:39], v13 offset:512
    s_waitcnt lgkmcnt(0)
    v_mfma_f32_32x32x16_bf16 v[48:63], v[16:19], v[32:35], v[48:63]
    ds_read_b128 v[24:27], v9 offset:0
    ds_read_b128 v[28:31], v9 offset:4096
    v_mfma_f32_32x32x16_bf16 v[64:79], v[16:19], v[36:39], v[64:79]
    ds_read_b64_tr_b16 v[40:41], v12 offset:2048
    ds_read_b64_tr_b16 v[42:43], v12 offset:2560
    v_mfma_f32_32x32x16_bf16 v[80:95], v[20:23], v[32:35], v[80:95]
    ds_read_b64_tr_b16 v[44:45], v13 offset:2048
    ds_read_b64_tr_b16 v[46:47], v13 offset:2560
    v_mfma_f32_32x32x16_bf16 v[96:111], v[20:23], v[36:39], v[96:111]
    s_waitcnt lgkmcnt(0)
    v_mfma_f32_32x32x16_bf16 v[48:63], v[24:27], v[40:43], v[48:63]
    ds_read_b128 v[16:19], v10 offset:0
    ds_read_b128 v[20:23], v10 offset:4096
    v_mfma_f32_32x32x16_bf16 v[64:79], v[24:27], v[44:47], v[64:79]
    ds_read_b64_tr_b16 v[32:33], v12 offset:4096
    ds_read_b64_tr_b16 v[34:35], v12 offset:4608
    v_mfma_f32_32x32x16_bf16 v[80:95], v[28:31], v[40:43], v[80:95]
    ds_read_b64_tr_b16 v[36:37], v13 offset:4096
    ds_read_b64_tr_b16 v[38:39], v13 offset:4608
    v_mfma_f32_32x32x16_bf16 v[96:111], v[28:31], v[44:47], v[96:111]
    s_waitcnt lgkmcnt(0)
    v_mfma_f32_32x32x16_bf16 v[48:63], v[16:19], v[32:35], v[48:63]
    ds_read_b128 v[24:27], v11 offset:0
    ds_read_b128 v[28:31], v11 offset:4096
    v_mfma_f32_32x32x16_bf16 v[64:79], v[16:19], v[36:39], v[64:79]
    ds_read_b64_tr_b16 v[40:41], v12 offset:6144
    ds_read_b64_tr_b16 v[42:43], v12 offset:6656
    v_mfma_f32_32x32x16_bf16 v[80:95], v[20:23], v[32:35], v[80:95]
    ds_read_b64_tr_b16 v[44:45], v13 offset:6144
    ds_read_b64_tr_b16 v[46:47], v13 offset:6656
    v_mfma_f32_32x32x16_bf16 v[96:111], v[20:23], v[36:39], v[96:111]
    s_waitcnt lgkmcnt(0)
    s_barrier
    v_add_u32 v8, 0xc000, v8
    v_add_u32 v9, 0xc000, v9
    v_add_u32 v10, 0xc000, v10
    v_add_u32 v11, 0xc000, v11
    v_add_u32 v12, 0xc000, v12
    v_add_u32 v13, 0xc000, v13
    v_mfma_f32_32x32x16_bf16 v[48:63], v[24:27], v[40:43], v[48:63]
    ds_read_b128 v[16:19], v8 offset:0
    ds_read_b128 v[20:23], v8 offset:4096
    v_mfma_f32_32x32x16_bf16 v[64:79], v[24:27], v[44:47], v[64:79]
    ds_read_b64_tr_b16 v[32:33], v12 offset:0
    ds_read_b64_tr_b16 v[34:35], v12 offset:512
    v_mfma_f32_32x32x16_bf16 v[80:95], v[28:31], v[40:43], v[80:95]
    ds_read_b64_tr_b16 v[36:37], v13 offset:0
    ds_read_b64_tr_b16 v[38:39], v13 offset:512
    v_mfma_f32_32x32x16_bf16 v[96:111], v[28:31], v[44:47], v[96:111]
    s_waitcnt lgkmcnt(0)
    v_mfma_f32_32x32x16_bf16 v[48:63], v[16:19], v[32:35], v[48:63]
    ds_read_b128 v[24:27], v9 offset:0
    ds_read_b128 v[28:31], v9 offset:4096
    v_mfma_f32_32x32x16_bf16 v[64:79], v[16:19], v[36:39], v[64:79]
    ds_read_b64_tr_b16 v[40:41], v12 offset:2048
    ds_read_b64_tr_b16 v[42:43], v12 offset:2560
    v_mfma_f32_32x32x16_bf16 v[80:95], v[20:23], v[32:35], v[80:95]
    ds_read_b64_tr_b16 v[44:45], v13 offset:2048
    ds_read_b64_tr_b16 v[46:47], v13 offset:2560
    v_mfma_f32_32x32x16_bf16 v[96:111], v[20:23], v[36:39], v[96:111]
    s_waitcnt lgkmcnt(0)
    v_mfma_f32_32x32x16_bf16 v[48:63], v[24:27], v[40:43], v[48:63]
    ds_read_b128 v[16:19], v10 offset:0
    ds_read_b128 v[20:23], v10 offset:4096
    v_mfma_f32_32x32x16_bf16 v[64:79], v[24:27], v[44:47], v[64:79]
    ds_read_b64_tr_b16 v[32:33], v12 offset:4096
    ds_read_b64_tr_b16 v[34:35], v12 offset:4608
    v_mfma_f32_32x32x16_bf16 v[80:95], v[28:31], v[40:43], v[80:95]
    ds_read_b64_tr_b16 v[36:37], v13 offset:4096
    ds_read_b64_tr_b16 v[38:39], v13 offset:4608
    v_mfma_f32_32x32x16_bf16 v[96:111], v[28:31], v[44:47], v[96:111]
    s_waitcnt lgkmcnt(0)
    v_mfma_f32_32x32x16_bf16 v[48:63], v[16:19], v[32:35], v[48:63]
    ds_read_b128 v[24:27], v11 offset:0
    ds_read_b128 v[28:31], v11 offset:4096
    v_mfma_f32_32x32x16_bf16 v[64:79], v[16:19], v[36:39], v[64:79]
    ds_read_b64_tr_b16 v[40:41], v12 offset:6144
    ds_read_b64_tr_b16 v[42:43], v12 offset:6656
    v_mfma_f32_32x32x16_bf16 v[80:95], v[20:23], v[32:35], v[80:95]
    ds_read_b64_tr_b16 v[44:45], v13 offset:6144
    ds_read_b64_tr_b16 v[46:47], v13 offset:6656
    v_mfma_f32_32x32x16_bf16 v[96:111], v[20:23], v[36:39], v[96:111]
    s_waitcnt lgkmcnt(0)
    s_barrier
    v_add_u32 v8, 0xc000, v8
    v_add_u32 v9, 0xc000, v9
    v_add_u32 v10, 0xc000, v10
    v_add_u32 v11, 0xc000, v11
    v_add_u32 v12, 0xc000, v12
    v_add_u32 v13, 0xc000, v13
    v_mfma_f32_32x32x16_bf16 v[48:63], v[24:27], v[40:43], v[48:63]
    ds_read_b128 v[16:19], v8 offset:0
    ds_read_b128 v[20:23], v8 offset:4096
    v_mfma_f32_32x32x16_bf16 v[64:79], v[24:27], v[44:47], v[64:79]
    ds_read_b64_tr_b16 v[32:33], v12 offset:0
    ds_read_b64_tr_b16 v[34:35], v12 offset:512
    v_mfma_f32_32x32x16_bf16 v[80:95], v[28:31], v[40:43], v[80:95]
    ds_read_b64_tr_b16 v[36:37], v13 offset:0
    ds_read_b64_tr_b16 v[38:39], v13 offset:512
    v_mfma_f32_32x32x16_bf16 v[96:111], v[28:31], v[44:47], v[96:111]
    s_waitcnt lgkmcnt(0)
    v_mfma_f32_32x32x16_bf16 v[48:63], v[16:19], v[32:35], v[48:63]
    ds_read_b128 v[24:27], v9 offset:0
    ds_read_b128 v[28:31], v9 offset:4096
    v_mfma_f32_32x32x16_bf16 v[64:79], v[16:19], v[36:39], v[64:79]
    ds_read_b64_tr_b16 v[40:41], v12 offset:2048
    ds_read_b64_tr_b16 v[42:43], v12 offset:2560
    v_mfma_f32_32x32x16_bf16 v[80:95], v[20:23], v[32:35], v[80:95]
    ds_read_b64_tr_b16 v[44:45], v13 offset:2048
    ds_read_b64_tr_b16 v[46:47], v13 offset:2560
    v_mfma_f32_32x32x16_bf16 v[96:111], v[20:23], v[36:39], v[96:111]
    s_waitcnt lgkmcnt(0)
    v_mfma_f32_32x32x16_bf16 v[48:63], v[24:27], v[40:43], v[48:63]
    ds_read_b128 v[16:19], v10 offset:0
    ds_read_b128 v[20:23], v10 offset:4096
    v_mfma_f32_32x32x16_bf16 v[64:79], v[24:27], v[44:47], v[64:79]
    ds_read_b64_tr_b16 v[32:33], v12 offset:4096
    ds_read_b64_tr_b16 v[34:35], v12 offset:4608
    v_mfma_f32_32x32x16_bf16 v[80:95], v[28:31], v[40:43], v[80:95]
    ds_read_b64_tr_b16 v[36:37], v13 offset:4096
    ds_read_b64_tr_b16 v[38:39], v13 offset:4608
    v_mfma_f32_32x32x16_bf16 v[96:111], v[28:31], v[44:47], v[96:111]
    s_waitcnt lgkmcnt(0)
    v_mfma_f32_32x32x16_bf16 v[48:63], v[16:19], v[32:35], v[48:63]
    ds_read_b128 v[24:27], v11 offset:0
    ds_read_b128 v[28:31], v11 offset:4096
    v_mfma_f32_32x32x16_bf16 v[64:79], v[16:19], v[36:39], v[64:79]
    ds_read_b64_tr_b16 v[40:41], v12 offset:6144
    ds_read_b64_tr_b16 v[42:43], v12 offset:6656
    v_mfma_f32_32x32x16_bf16 v[80:95], v[20:23], v[32:35], v[80:95]
    ds_read_b64_tr_b16 v[44:45], v13 offset:6144
    ds_read_b64_tr_b16 v[46:47], v13 offset:6656
    v_mfma_f32_32x32x16_bf16 v[96:111], v[20:23], v[36:39], v[96:111]
    s_waitcnt lgkmcnt(0)
    s_barrier
    v_add_u32 v8, 0xfffe8000, v8
    v_add_u32 v9, 0xfffe8000, v9
    v_add_u32 v10, 0xfffe8000, v10
    v_add_u32 v11, 0xfffe8000, v11
    v_add_u32 v12, 0xfffe8000, v12
    v_add_u32 v13, 0xfffe8000, v13
    v_mfma_f32_32x32x16_bf16 v[48:63], v[24:27], v[40:43], v[48:63]
    ds_read_b128 v[16:19], v8 offset:0
    ds_read_b128 v[20:23], v8 offset:4096
    v_mfma_f32_32x32x16_bf16 v[64:79], v[24:27], v[44:47], v[64:79]
    ds_read_b64_tr_b16 v[32:33], v12 offset:0
    ds_read_b64_tr_b16 v[34:35], v12 offset:512
    v_mfma_f32_32x32x16_bf16 v[80:95], v[28:31], v[40:43], v[80:95]
    ds_read_b64_tr_b16 v[36:37], v13 offset:0
    ds_read_b64_tr_b16 v[38:39], v13 offset:512
    v_mfma_f32_32x32x16_bf16 v[96:111], v[28:31], v[44:47], v[96:111]
    s_waitcnt lgkmcnt(0)
    v_mfma_f32_32x32x16_bf16 v[48:63], v[16:19], v[32:35], v[48:63]
    ds_read_b128 v[24:27], v9 offset:0
    ds_read_b128 v[28:31], v9 offset:4096
    v_mfma_f32_32x32x16_bf16 v[64:79], v[16:19], v[36:39], v[64:79]
    ds_read_b64_tr_b16 v[40:41], v12 offset:2048
    ds_read_b64_tr_b16 v[42:43], v12 offset:2560
    v_mfma_f32_32x32x16_bf16 v[80:95], v[20:23], v[32:35], v[80:95]
    ds_read_b64_tr_b16 v[44:45], v13 offset:2048
    ds_read_b64_tr_b16 v[46:47], v13 offset:2560
    v_mfma_f32_32x32x16_bf16 v[96:111], v[20:23], v[36:39], v[96:111]
    s_waitcnt lgkmcnt(0)
    v_mfma_f32_32x32x16_bf16 v[48:63], v[24:27], v[40:43], v[48:63]
    ds_read_b128 v[16:19], v10 offset:0
    ds_read_b128 v[20:23], v10 offset:4096
    v_mfma_f32_32x32x16_bf16 v[64:79], v[24:27], v[44:47], v[64:79]
    ds_read_b64_tr_b16 v[32:33], v12 offset:4096
    ds_read_b64_tr_b16 v[34:35], v12 offset:4608
    v_mfma_f32_32x32x16_bf16 v[80:95], v[28:31], v[40:43], v[80:95]
    ds_read_b64_tr_b16 v[36:37], v13 offset:4096
    ds_read_b64_tr_b16 v[38:39], v13 offset:4608
    v_mfma_f32_32x32x16_bf16 v[96:111], v[28:31], v[44:47], v[96:111]
    s_waitcnt lgkmcnt(0)
    v_mfma_f32_32x32x16_bf16 v[48:63], v[16:19], v[32:35], v[48:63]
    ds_read_b128 v[24:27], v11 offset:0
    ds_read_b128 v[28:31], v11 offset:4096
    v_mfma_f32_32x32x16_bf16 v[64:79], v[16:19], v[36:39], v[64:79]
    ds_read_b64_tr_b16 v[40:41], v12 offset:6144
    ds_read_b64_tr_b16 v[42:43], v12 offset:6656
    v_mfma_f32_32x32x16_bf16 v[80:95], v[20:23], v[32:35], v[80:95]
    ds_read_b64_tr_b16 v[44:45], v13 offset:6144
    ds_read_b64_tr_b16 v[46:47], v13 offset:6656
    v_mfma_f32_32x32x16_bf16 v[96:111], v[20:23], v[36:39], v[96:111]
    s_waitcnt lgkmcnt(0)
    s_barrier
    v_add_u32 v8, 0xc000, v8
    v_add_u32 v9, 0xc000, v9
    v_add_u32 v10, 0xc000, v10
    v_add_u32 v11, 0xc000, v11
    v_add_u32 v12, 0xc000, v12
    v_add_u32 v13, 0xc000, v13
    v_mfma_f32_32x32x16_bf16 v[48:63], v[24:27], v[40:43], v[48:63]
    ds_read_b128 v[16:19], v8 offset:0
    ds_read_b128 v[20:23], v8 offset:4096
    v_mfma_f32_32x32x16_bf16 v[64:79], v[24:27], v[44:47], v[64:79]
    ds_read_b64_tr_b16 v[32:33], v12 offset:0
    ds_read_b64_tr_b16 v[34:35], v12 offset:512
    v_mfma_f32_32x32x16_bf16 v[80:95], v[28:31], v[40:43], v[80:95]
    ds_read_b64_tr_b16 v[36:37], v13 offset:0
    ds_read_b64_tr_b16 v[38:39], v13 offset:512
    v_mfma_f32_32x32x16_bf16 v[96:111], v[28:31], v[44:47], v[96:111]
    s_waitcnt lgkmcnt(0)
    v_mfma_f32_32x32x16_bf16 v[48:63], v[16:19], v[32:35], v[48:63]
    ds_read_b128 v[24:27], v9 offset:0
    ds_read_b128 v[28:31], v9 offset:4096
    v_mfma_f32_32x32x16_bf16 v[64:79], v[16:19], v[36:39], v[64:79]
    ds_read_b64_tr_b16 v[40:41], v12 offset:2048
    ds_read_b64_tr_b16 v[42:43], v12 offset:2560
    v_mfma_f32_32x32x16_bf16 v[80:95], v[20:23], v[32:35], v[80:95]
    ds_read_b64_tr_b16 v[44:45], v13 offset:2048
    ds_read_b64_tr_b16 v[46:47], v13 offset:2560
    v_mfma_f32_32x32x16_bf16 v[96:111], v[20:23], v[36:39], v[96:111]
    s_waitcnt lgkmcnt(0)
    v_mfma_f32_32x32x16_bf16 v[48:63], v[24:27], v[40:43], v[48:63]
    ds_read_b128 v[16:19], v10 offset:0
    ds_read_b128 v[20:23], v10 offset:4096
    v_mfma_f32_32x32x16_bf16 v[64:79], v[24:27], v[44:47], v[64:79]
    ds_read_b64_tr_b16 v[32:33], v12 offset:4096
    ds_read_b64_tr_b16 v[34:35], v12 offset:4608
    v_mfma_f32_32x32x16_bf16 v[80:95], v[28:31], v[40:43], v[80:95]
    ds_read_b64_tr_b16 v[36:37], v13 offset:4096
    ds_read_b64_tr_b16 v[38:39], v13 offset:4608
    v_mfma_f32_32x32x16_bf16 v[96:111], v[28:31], v[44:47], v[96:111]
    s_waitcnt lgkmcnt(0)
    v_mfma_f32_32x32x16_bf16 v[48:63], v[16:19], v[32:35], v[48:63]
    ds_read_b128 v[24:27], v11 offset:0
    ds_read_b128 v[28:31], v11 offset:4096
    v_mfma_f32_32x32x16_bf16 v[64:79], v[16:19], v[36:39], v[64:79]
    ds_read_b64_tr_b16 v[40:41], v12 offset:6144
    ds_read_b64_tr_b16 v[42:43], v12 offset:6656
    v_mfma_f32_32x32x16_bf16 v[80:95], v[20:23], v[32:35], v[80:95]
    ds_read_b64_tr_b16 v[44:45], v13 offset:6144
    ds_read_b64_tr_b16 v[46:47], v13 offset:6656
    v_mfma_f32_32x32x16_bf16 v[96:111], v[20:23], v[36:39], v[96:111]
    s_waitcnt lgkmcnt(0)
    s_barrier
    v_add_u32 v8, 0xc000, v8
    v_add_u32 v9, 0xc000, v9
    v_add_u32 v10, 0xc000, v10
    v_add_u32 v11, 0xc000, v11
    v_add_u32 v12, 0xc000, v12
    v_add_u32 v13, 0xc000, v13
    v_mfma_f32_32x32x16_bf16 v[48:63], v[24:27], v[40:43], v[48:63]
    ds_read_b128 v[16:19], v8 offset:0
    ds_read_b128 v[20:23], v8 offset:4096
    v_mfma_f32_32x32x16_bf16 v[64:79], v[24:27], v[44:47], v[64:79]
    ds_read_b64_tr_b16 v[32:33], v12 offset:0
    ds_read_b64_tr_b16 v[34:35], v12 offset:512
    v_mfma_f32_32x32x16_bf16 v[80:95], v[28:31], v[40:43], v[80:95]
    ds_read_b64_tr_b16 v[36:37], v13 offset:0
    ds_read_b64_tr_b16 v[38:39], v13 offset:512
    v_mfma_f32_32x32x16_bf16 v[96:111], v[28:31], v[44:47], v[96:111]
    s_waitcnt lgkmcnt(0)
    v_mfma_f32_32x32x16_bf16 v[48:63], v[16:19], v[32:35], v[48:63]
    ds_read_b128 v[24:27], v9 offset:0
    ds_read_b128 v[28:31], v9 offset:4096
    v_mfma_f32_32x32x16_bf16 v[64:79], v[16:19], v[36:39], v[64:79]
    ds_read_b64_tr_b16 v[40:41], v12 offset:2048
    ds_read_b64_tr_b16 v[42:43], v12 offset:2560
    v_mfma_f32_32x32x16_bf16 v[80:95], v[20:23], v[32:35], v[80:95]
    ds_read_b64_tr_b16 v[44:45], v13 offset:2048
    ds_read_b64_tr_b16 v[46:47], v13 offset:2560
    v_mfma_f32_32x32x16_bf16 v[96:111], v[20:23], v[36:39], v[96:111]
    s_waitcnt lgkmcnt(0)
    v_mfma_f32_32x32x16_bf16 v[48:63], v[24:27], v[40:43], v[48:63]
    ds_read_b128 v[16:19], v10 offset:0
    ds_read_b128 v[20:23], v10 offset:4096
    v_mfma_f32_32x32x16_bf16 v[64:79], v[24:27], v[44:47], v[64:79]
    ds_read_b64_tr_b16 v[32:33], v12 offset:4096
    ds_read_b64_tr_b16 v[34:35], v12 offset:4608
    v_mfma_f32_32x32x16_bf16 v[80:95], v[28:31], v[40:43], v[80:95]
    ds_read_b64_tr_b16 v[36:37], v13 offset:4096
    ds_read_b64_tr_b16 v[38:39], v13 offset:4608
    v_mfma_f32_32x32x16_bf16 v[96:111], v[28:31], v[44:47], v[96:111]
    s_waitcnt lgkmcnt(0)
    v_mfma_f32_32x32x16_bf16 v[48:63], v[16:19], v[32:35], v[48:63]
    ds_read_b128 v[24:27], v11 offset:0
    ds_read_b128 v[28:31], v11 offset:4096
    v_mfma_f32_32x32x16_bf16 v[64:79], v[16:19], v[36:39], v[64:79]
    ds_read_b64_tr_b16 v[40:41], v12 offset:6144
    ds_read_b64_tr_b16 v[42:43], v12 offset:6656
    v_mfma_f32_32x32x16_bf16 v[80:95], v[20:23], v[32:35], v[80:95]
    ds_read_b64_tr_b16 v[44:45], v13 offset:6144
    ds_read_b64_tr_b16 v[46:47], v13 offset:6656
    v_mfma_f32_32x32x16_bf16 v[96:111], v[20:23], v[36:39], v[96:111]
    s_waitcnt lgkmcnt(0)
    s_barrier
    v_add_u32 v8, 0xfffe8000, v8
    v_add_u32 v9, 0xfffe8000, v9
    v_add_u32 v10, 0xfffe8000, v10
    v_add_u32 v11, 0xfffe8000, v11
    v_add_u32 v12, 0xfffe8000, v12
    v_add_u32 v13, 0xfffe8000, v13
    v_mfma_f32_32x32x16_bf16 v[48:63], v[24:27], v[40:43], v[48:63]
    ds_read_b128 v[16:19], v8 offset:0
    ds_read_b128 v[20:23], v8 offset:4096
    v_mfma_f32_32x32x16_bf16 v[64:79], v[24:27], v[44:47], v[64:79]
    ds_read_b64_tr_b16 v[32:33], v12 offset:0
    ds_read_b64_tr_b16 v[34:35], v12 offset:512
    v_mfma_f32_32x32x16_bf16 v[80:95], v[28:31], v[40:43], v[80:95]
    ds_read_b64_tr_b16 v[36:37], v13 offset:0
    ds_read_b64_tr_b16 v[38:39], v13 offset:512
    v_mfma_f32_32x32x16_bf16 v[96:111], v[28:31], v[44:47], v[96:111]
    s_waitcnt lgkmcnt(0)
    v_mfma_f32_32x32x16_bf16 v[48:63], v[16:19], v[32:35], v[48:63]
    ds_read_b128 v[24:27], v9 offset:0
    ds_read_b128 v[28:31], v9 offset:4096
    v_mfma_f32_32x32x16_bf16 v[64:79], v[16:19], v[36:39], v[64:79]
    ds_read_b64_tr_b16 v[40:41], v12 offset:2048
    ds_read_b64_tr_b16 v[42:43], v12 offset:2560
    v_mfma_f32_32x32x16_bf16 v[80:95], v[20:23], v[32:35], v[80:95]
    ds_read_b64_tr_b16 v[44:45], v13 offset:2048
    ds_read_b64_tr_b16 v[46:47], v13 offset:2560
    v_mfma_f32_32x32x16_bf16 v[96:111], v[20:23], v[36:39], v[96:111]
    s_waitcnt lgkmcnt(0)
    v_mfma_f32_32x32x16_bf16 v[48:63], v[24:27], v[40:43], v[48:63]
    ds_read_b128 v[16:19], v10 offset:0
    ds_read_b128 v[20:23], v10 offset:4096
    v_mfma_f32_32x32x16_bf16 v[64:79], v[24:27], v[44:47], v[64:79]
    ds_read_b64_tr_b16 v[32:33], v12 offset:4096
    ds_read_b64_tr_b16 v[34:35], v12 offset:4608
    v_mfma_f32_32x32x16_bf16 v[80:95], v[28:31], v[40:43], v[80:95]
    ds_read_b64_tr_b16 v[36:37], v13 offset:4096
    ds_read_b64_tr_b16 v[38:39], v13 offset:4608
    v_mfma_f32_32x32x16_bf16 v[96:111], v[28:31], v[44:47], v[96:111]
    s_waitcnt lgkmcnt(0)
    v_mfma_f32_32x32x16_bf16 v[48:63], v[16:19], v[32:35], v[48:63]
    ds_read_b128 v[24:27], v11 offset:0
    ds_read_b128 v[28:31], v11 offset:4096
    v_mfma_f32_32x32x16_bf16 v[64:79], v[16:19], v[36:39], v[64:79]
    ds_read_b64_tr_b16 v[40:41], v12 offset:6144
    ds_read_b64_tr_b16 v[42:43], v12 offset:6656
    v_mfma_f32_32x32x16_bf16 v[80:95], v[20:23], v[32:35], v[80:95]
    ds_read_b64_tr_b16 v[44:45], v13 offset:6144
    ds_read_b64_tr_b16 v[46:47], v13 offset:6656
    v_mfma_f32_32x32x16_bf16 v[96:111], v[20:23], v[36:39], v[96:111]
    s_waitcnt lgkmcnt(0)
    s_barrier
    v_add_u32 v8, 0xc000, v8
    v_add_u32 v9, 0xc000, v9
    v_add_u32 v10, 0xc000, v10
    v_add_u32 v11, 0xc000, v11
    v_add_u32 v12, 0xc000, v12
    v_add_u32 v13, 0xc000, v13
    v_mfma_f32_32x32x16_bf16 v[48:63], v[24:27], v[40:43], v[48:63]
    ds_read_b128 v[16:19], v8 offset:0
    ds_read_b128 v[20:23], v8 offset:4096
    v_mfma_f32_32x32x16_bf16 v[64:79], v[24:27], v[44:47], v[64:79]
    ds_read_b64_tr_b16 v[32:33], v12 offset:0
    ds_read_b64_tr_b16 v[34:35], v12 offset:512
    v_mfma_f32_32x32x16_bf16 v[80:95], v[28:31], v[40:43], v[80:95]
    ds_read_b64_tr_b16 v[36:37], v13 offset:0
    ds_read_b64_tr_b16 v[38:39], v13 offset:512
    v_mfma_f32_32x32x16_bf16 v[96:111], v[28:31], v[44:47], v[96:111]
    v_and_b32 v1, 31, v0
    v_lshlrev_b32 v2, 4, v1
    s_lshl_b32 s58, s44, 7
    s_add_u32 s58, s58, s41
    s_lshl_b32 s59, s58, 4
    s_add_u32 s59, s59, 18874368
    buffer_load_dwordx4 v[120:123], v2, s[24:27], s59 offen offset:0 sc1
    buffer_load_dwordx4 v[124:127], v2, s[24:27], s59 offen offset:512 sc1
    v_lshlrev_b32 v3, 2, v1
    s_lshl_b32 s59, s46, 4
    s_lshl_b32 s60, s59, 2
    s_add_u32 s60, s60, 18915328
    buffer_load_dword v160, v3, s[24:27], s60 offen offset:0 sc1
    buffer_load_dword v161, v3, s[24:27], s60 offen offset:128 sc1
    v_lshrrev_b32 v4, 5, v0
    v_lshlrev_b32 v4, 4, v4
    s_lshl_b32 s60, s58, 2
    s_add_u32 s60, s60, 18907136
    buffer_load_dwordx4 v[128:131], v4, s[24:27], s60 offen offset:0 sc1
    buffer_load_dwordx4 v[132:135], v4, s[24:27], s60 offen offset:32 sc1
    buffer_load_dwordx4 v[136:139], v4, s[24:27], s60 offen offset:64 sc1
    buffer_load_dwordx4 v[140:143], v4, s[24:27], s60 offen offset:96 sc1
    buffer_load_dwordx4 v[144:147], v4, s[24:27], s60 offen offset:128 sc1
    buffer_load_dwordx4 v[148:151], v4, s[24:27], s60 offen offset:160 sc1
    buffer_load_dwordx4 v[152:155], v4, s[24:27], s60 offen offset:192 sc1
    buffer_load_dwordx4 v[156:159], v4, s[24:27], s60 offen offset:224 sc1
    s_waitcnt lgkmcnt(0)
    v_mfma_f32_32x32x16_bf16 v[48:63], v[16:19], v[32:35], v[48:63]
    ds_read_b128 v[24:27], v9 offset:0
    ds_read_b128 v[28:31], v9 offset:4096
    v_mfma_f32_32x32x16_bf16 v[64:79], v[16:19], v[36:39], v[64:79]
    ds_read_b64_tr_b16 v[40:41], v12 offset:2048
    ds_read_b64_tr_b16 v[42:43], v12 offset:2560
    v_mfma_f32_32x32x16_bf16 v[80:95], v[20:23], v[32:35], v[80:95]
    ds_read_b64_tr_b16 v[44:45], v13 offset:2048
    ds_read_b64_tr_b16 v[46:47], v13 offset:2560
    v_mfma_f32_32x32x16_bf16 v[96:111], v[20:23], v[36:39], v[96:111]
    s_waitcnt lgkmcnt(0)
    v_mfma_f32_32x32x16_bf16 v[48:63], v[24:27], v[40:43], v[48:63]
    ds_read_b128 v[16:19], v10 offset:0
    ds_read_b128 v[20:23], v10 offset:4096
    v_mfma_f32_32x32x16_bf16 v[64:79], v[24:27], v[44:47], v[64:79]
    ds_read_b64_tr_b16 v[32:33], v12 offset:4096
    ds_read_b64_tr_b16 v[34:35], v12 offset:4608
    v_mfma_f32_32x32x16_bf16 v[80:95], v[28:31], v[40:43], v[80:95]
    ds_read_b64_tr_b16 v[36:37], v13 offset:4096
    ds_read_b64_tr_b16 v[38:39], v13 offset:4608
    v_mfma_f32_32x32x16_bf16 v[96:111], v[28:31], v[44:47], v[96:111]
    s_waitcnt lgkmcnt(0)
    v_mfma_f32_32x32x16_bf16 v[48:63], v[16:19], v[32:35], v[48:63]
    ds_read_b128 v[24:27], v11 offset:0
    ds_read_b128 v[28:31], v11 offset:4096
    v_mfma_f32_32x32x16_bf16 v[64:79], v[16:19], v[36:39], v[64:79]
    ds_read_b64_tr_b16 v[40:41], v12 offset:6144
    ds_read_b64_tr_b16 v[42:43], v12 offset:6656
    v_mfma_f32_32x32x16_bf16 v[80:95], v[20:23], v[32:35], v[80:95]
    ds_read_b64_tr_b16 v[44:45], v13 offset:6144
    ds_read_b64_tr_b16 v[46:47], v13 offset:6656
    v_mfma_f32_32x32x16_bf16 v[96:111], v[20:23], v[36:39], v[96:111]
    s_waitcnt lgkmcnt(0)
    v_mfma_f32_32x32x16_bf16 v[48:63], v[24:27], v[40:43], v[48:63]
    v_mfma_f32_32x32x16_bf16 v[64:79], v[24:27], v[44:47], v[64:79]
    v_mfma_f32_32x32x16_bf16 v[80:95], v[28:31], v[40:43], v[80:95]
    v_mfma_f32_32x32x16_bf16 v[96:111], v[28:31], v[44:47], v[96:111]
    s_mov_b32 s60, -1
    s_mov_b32 s61, 0
    s_waitcnt vmcnt(0)
    v_mov_b32 v122, 0
    v_mov_b32 v123, 0
    v_mov_b32 v126, 0
    v_mov_b32 v127, 0
    v_cvt_pk_bf16_f32 v1, v160, v160
    v_lshlrev_b32 v1, 16, v1
    v_sub_f32 v1, v160, v1
    v_cvt_pk_bf16_f32 v1, v160, v1
    v_cndmask_b32 v112, 0, v1, s[60:61]
    v_mov_b32 v113, 0
    v_mov_b32 v114, 0
    v_mov_b32 v115, 0
    v_cvt_pk_bf16_f32 v1, v161, v161
    v_lshlrev_b32 v1, 16, v1
    v_sub_f32 v1, v161, v1
    v_cvt_pk_bf16_f32 v1, v161, v1
    v_cndmask_b32 v116, 0, v1, s[60:61]
    v_mov_b32 v117, 0
    v_mov_b32 v118, 0
    v_mov_b32 v119, 0
    s_nop 1
    v_mfma_f32_32x32x16_bf16 v[48:63], v[120:123], v[112:115], v[48:63]
    v_mfma_f32_32x32x16_bf16 v[64:79], v[120:123], v[116:119], v[64:79]
    v_mfma_f32_32x32x16_bf16 v[80:95], v[124:127], v[112:115], v[80:95]
    v_mfma_f32_32x32x16_bf16 v[96:111], v[124:127], v[116:119], v[96:111]
    v_lshlrev_b32 v7, 4, v0
    s_lshl_b32 s58, s44, 2
    s_lshr_b32 s59, s41, 5
    s_add_u32 s58, s58, s59
    s_mov_b32 s59, s46
    v_and_b32 v1, 15, v0
    v_lshlrev_b32 v1, 4, v1
    v_lshrrev_b32 v2, 5, v0
    v_lshl_add_u32 v1, v2, 8, v1
    v_bfe_u32 v2, v0, 4, 1
    v_lshl_add_u32 v6, v2, 16, v1
    s_nop 4
    s_add_u32 s62, s59, 0
    s_lshl_b32 s62, s62, 16
    s_add_u32 s63, s58, 0
    s_lshl_b32 s63, s63, 10
    s_add_u32 s62, s62, s63
    v_mul_f32 v48, v48, v128
    v_mul_f32 v49, v49, v129
    v_mul_f32 v50, v50, v130
    v_mul_f32 v51, v51, v131
    v_mul_f32 v52, v52, v132
    v_mul_f32 v53, v53, v133
    v_mul_f32 v54, v54, v134
    v_mul_f32 v55, v55, v135
    v_cvt_pk_bf16_f32 v16, v48, v49
    v_cvt_pk_bf16_f32 v17, v50, v51
    v_cvt_pk_bf16_f32 v18, v52, v53
    v_cvt_pk_bf16_f32 v19, v54, v55
    buffer_store_dwordx4 v[16:19], v6, s[24:27], s62 offen offset:0 sc1
    v_mul_f32 v56, v56, v136
    v_mul_f32 v57, v57, v137
    v_mul_f32 v58, v58, v138
    v_mul_f32 v59, v59, v139
    v_mul_f32 v60, v60, v140
    v_mul_f32 v61, v61, v141
    v_mul_f32 v62, v62, v142
    v_mul_f32 v63, v63, v143
    v_cvt_pk_bf16_f32 v20, v56, v57
    v_cvt_pk_bf16_f32 v21, v58, v59
    v_cvt_pk_bf16_f32 v22, v60, v61
    v_cvt_pk_bf16_f32 v23, v62, v63
    buffer_store_dwordx4 v[20:23], v6, s[24:27], s62 offen offset:512 sc1
    s_add_u32 s62, s59, 2
    s_lshl_b32 s62, s62, 16
    s_add_u32 s63, s58, 0
    s_lshl_b32 s63, s63, 10
    s_add_u32 s62, s62, s63
    v_mul_f32 v64, v64, v128
    v_mul_f32 v65, v65, v129
    v_mul_f32 v66, v66, v130
    v_mul_f32 v67, v67, v131
    v_mul_f32 v68, v68, v132
    v_mul_f32 v69, v69, v133
    v_mul_f32 v70, v70, v134
    v_mul_f32 v71, v71, v135
    v_cvt_pk_bf16_f32 v32, v64, v65
    v_cvt_pk_bf16_f32 v33, v66, v67
    v_cvt_pk_bf16_f32 v34, v68, v69
    v_cvt_pk_bf16_f32 v35, v70, v71
    buffer_store_dwordx4 v[32:35], v6, s[24:27], s62 offen offset:0 sc1
    v_mul_f32 v72, v72, v136
    v_mul_f32 v73, v73, v137
    v_mul_f32 v74, v74, v138
    v_mul_f32 v75, v75, v139
    v_mul_f32 v76, v76, v140
    v_mul_f32 v77, v77, v141
    v_mul_f32 v78, v78, v142
    v_mul_f32 v79, v79, v143
    v_cvt_pk_bf16_f32 v36, v72, v73
    v_cvt_pk_bf16_f32 v37, v74, v75
    v_cvt_pk_bf16_f32 v38, v76, v77
    v_cvt_pk_bf16_f32 v39, v78, v79
    buffer_store_dwordx4 v[36:39], v6, s[24:27], s62 offen offset:512 sc1
    s_add_u32 s62, s59, 0
    s_lshl_b32 s62, s62, 16
    s_add_u32 s63, s58, 1
    s_lshl_b32 s63, s63, 10
    s_add_u32 s62, s62, s63
    v_mul_f32 v80, v80, v144
    v_mul_f32 v81, v81, v145
    v_mul_f32 v82, v82, v146
    v_mul_f32 v83, v83, v147
    v_mul_f32 v84, v84, v148
    v_mul_f32 v85, v85, v149
    v_mul_f32 v86, v86, v150
    v_mul_f32 v87, v87, v151
    v_cvt_pk_bf16_f32 v16, v80, v81
    v_cvt_pk_bf16_f32 v17, v82, v83
    v_cvt_pk_bf16_f32 v18, v84, v85
    v_cvt_pk_bf16_f32 v19, v86, v87
    buffer_store_dwordx4 v[16:19], v6, s[24:27], s62 offen offset:0 sc1
    v_mul_f32 v88, v88, v152
    v_mul_f32 v89, v89, v153
    v_mul_f32 v90, v90, v154
    v_mul_f32 v91, v91, v155
    v_mul_f32 v92, v92, v156
    v_mul_f32 v93, v93, v157
    v_mul_f32 v94, v94, v158
    v_mul_f32 v95, v95, v159
    v_cvt_pk_bf16_f32 v20, v88, v89
    v_cvt_pk_bf16_f32 v21, v90, v91
    v_cvt_pk_bf16_f32 v22, v92, v93
    v_cvt_pk_bf16_f32 v23, v94, v95
    buffer_store_dwordx4 v[20:23], v6, s[24:27], s62 offen offset:512 sc1
    s_add_u32 s62, s59, 2
    s_lshl_b32 s62, s62, 16
    s_add_u32 s63, s58, 1
    s_lshl_b32 s63, s63, 10
    s_add_u32 s62, s62, s63
    v_mul_f32 v96, v96, v144
    v_mul_f32 v97, v97, v145
    v_mul_f32 v98, v98, v146
    v_mul_f32 v99, v99, v147
    v_mul_f32 v100, v100, v148
    v_mul_f32 v101, v101, v149
    v_mul_f32 v102, v102, v150
    v_mul_f32 v103, v103, v151
    v_cvt_pk_bf16_f32 v32, v96, v97
    v_cvt_pk_bf16_f32 v33, v98, v99
    v_cvt_pk_bf16_f32 v34, v100, v101
    v_cvt_pk_bf16_f32 v35, v102, v103
    buffer_store_dwordx4 v[32:35], v6, s[24:27], s62 offen offset:0 sc1
    v_mul_f32 v104, v104, v152
    v_mul_f32 v105, v105, v153
    v_mul_f32 v106, v106, v154
    v_mul_f32 v107, v107, v155
    v_mul_f32 v108, v108, v156
    v_mul_f32 v109, v109, v157
    v_mul_f32 v110, v110, v158
    v_mul_f32 v111, v111, v159
    v_cvt_pk_bf16_f32 v36, v104, v105
    v_cvt_pk_bf16_f32 v37, v106, v107
    v_cvt_pk_bf16_f32 v38, v108, v109
    v_cvt_pk_bf16_f32 v39, v110, v111
    buffer_store_dwordx4 v[36:39], v6, s[24:27], s62 offen offset:512 sc1
    s_waitcnt vmcnt(0)
    s_barrier
    s_branch parallel_p2attn
parallel_idle1:
    s_waitcnt lgkmcnt(0)
    s_mov_b32 s16, s64
    s_mov_b32 s17, s65
    s_mov_b32 s18, 2097152
    s_mov_b32 s19, 0x20000
    s_sub_u32 s41, s86, 6
    s_lshl_b32 s56, s44, 7
    s_lshl_b32 s59, s45, 4
    s_add_u32 s56, s56, s59
    s_lshl_b32 s59, s41, 3
    s_add_u32 s56, s56, s59
    v_lshlrev_b32 v1, 4, v0
    s_lshl_b32 s59, s56, 10
    buffer_load_dwordx4 v[16:19], v1, s[16:19], s59 offen
    s_add_u32 s59, s59, 1024
    buffer_load_dwordx4 v[20:23], v1, s[16:19], s59 offen
    s_add_u32 s59, s59, 1024
    buffer_load_dwordx4 v[24:27], v1, s[16:19], s59 offen
    s_add_u32 s59, s59, 1024
    buffer_load_dwordx4 v[28:31], v1, s[16:19], s59 offen
    s_add_u32 s59, s59, 1024
    buffer_load_dwordx4 v[32:35], v1, s[16:19], s59 offen
    s_add_u32 s59, s59, 1024
    buffer_load_dwordx4 v[36:39], v1, s[16:19], s59 offen
    s_add_u32 s59, s59, 1024
    buffer_load_dwordx4 v[40:43], v1, s[16:19], s59 offen
    s_add_u32 s59, s59, 1024
    buffer_load_dwordx4 v[44:47], v1, s[16:19], s59 offen
    s_add_u32 s59, s59, 1024
    s_mov_b32 s24, s84
    s_mov_b32 s25, s85
    s_mov_b32 s26, 18956288
    s_mov_b32 s27, 0x20000
    s_mov_b32 s32, s82
    s_mov_b32 s33, s83
    s_mov_b32 s34, 256
    s_mov_b32 s35, 0x20000
    v_mov_b32 v2, 0x3f803f80
    s_lshl_b32 s60, s41, 12
    s_add_u32 s60, s60, 147456
    v_lshlrev_b32 v3, 2, v0
    v_add_u32 v3, s60, v3
    s_barrier
    s_waitcnt vmcnt(7)
    v_mov_b32 v4, 0
    v_mov_b32 v5, 0
    v_dot2_f32_bf16 v4, v16, v2, v4
    v_dot2_f32_bf16 v5, v16, v16, v5
    v_dot2_f32_bf16 v4, v17, v2, v4
    v_dot2_f32_bf16 v5, v17, v17, v5
    v_dot2_f32_bf16 v4, v18, v2, v4
    v_dot2_f32_bf16 v5, v18, v18, v5
    v_dot2_f32_bf16 v4, v19, v2, v4
    v_dot2_f32_bf16 v5, v19, v19, v5
    s_nop 2
    ds_write_b32 v3, v4 offset:0
    ds_write_b32 v3, v5 offset:2048
    s_waitcnt vmcnt(6)
    v_mov_b32 v4, 0
    v_mov_b32 v5, 0
    v_dot2_f32_bf16 v4, v20, v2, v4
    v_dot2_f32_bf16 v5, v20, v20, v5
    v_dot2_f32_bf16 v4, v21, v2, v4
    v_dot2_f32_bf16 v5, v21, v21, v5
    v_dot2_f32_bf16 v4, v22, v2, v4
    v_dot2_f32_bf16 v5, v22, v22, v5
    v_dot2_f32_bf16 v4, v23, v2, v4
    v_dot2_f32_bf16 v5, v23, v23, v5
    s_nop 2
    ds_write_b32 v3, v4 offset:256
    ds_write_b32 v3, v5 offset:2304
    s_waitcnt vmcnt(5)
    v_mov_b32 v4, 0
    v_mov_b32 v5, 0
    v_dot2_f32_bf16 v4, v24, v2, v4
    v_dot2_f32_bf16 v5, v24, v24, v5
    v_dot2_f32_bf16 v4, v25, v2, v4
    v_dot2_f32_bf16 v5, v25, v25, v5
    v_dot2_f32_bf16 v4, v26, v2, v4
    v_dot2_f32_bf16 v5, v26, v26, v5
    v_dot2_f32_bf16 v4, v27, v2, v4
    v_dot2_f32_bf16 v5, v27, v27, v5
    s_nop 2
    ds_write_b32 v3, v4 offset:512
    ds_write_b32 v3, v5 offset:2560
    s_waitcnt vmcnt(4)
    v_mov_b32 v4, 0
    v_mov_b32 v5, 0
    v_dot2_f32_bf16 v4, v28, v2, v4
    v_dot2_f32_bf16 v5, v28, v28, v5
    v_dot2_f32_bf16 v4, v29, v2, v4
    v_dot2_f32_bf16 v5, v29, v29, v5
    v_dot2_f32_bf16 v4, v30, v2, v4
    v_dot2_f32_bf16 v5, v30, v30, v5
    v_dot2_f32_bf16 v4, v31, v2, v4
    v_dot2_f32_bf16 v5, v31, v31, v5
    s_nop 2
    ds_write_b32 v3, v4 offset:768
    ds_write_b32 v3, v5 offset:2816
    s_waitcnt vmcnt(3)
    v_mov_b32 v4, 0
    v_mov_b32 v5, 0
    v_dot2_f32_bf16 v4, v32, v2, v4
    v_dot2_f32_bf16 v5, v32, v32, v5
    v_dot2_f32_bf16 v4, v33, v2, v4
    v_dot2_f32_bf16 v5, v33, v33, v5
    v_dot2_f32_bf16 v4, v34, v2, v4
    v_dot2_f32_bf16 v5, v34, v34, v5
    v_dot2_f32_bf16 v4, v35, v2, v4
    v_dot2_f32_bf16 v5, v35, v35, v5
    s_nop 2
    ds_write_b32 v3, v4 offset:1024
    ds_write_b32 v3, v5 offset:3072
    s_waitcnt vmcnt(2)
    v_mov_b32 v4, 0
    v_mov_b32 v5, 0
    v_dot2_f32_bf16 v4, v36, v2, v4
    v_dot2_f32_bf16 v5, v36, v36, v5
    v_dot2_f32_bf16 v4, v37, v2, v4
    v_dot2_f32_bf16 v5, v37, v37, v5
    v_dot2_f32_bf16 v4, v38, v2, v4
    v_dot2_f32_bf16 v5, v38, v38, v5
    v_dot2_f32_bf16 v4, v39, v2, v4
    v_dot2_f32_bf16 v5, v39, v39, v5
    s_nop 2
    ds_write_b32 v3, v4 offset:1280
    ds_write_b32 v3, v5 offset:3328
    s_waitcnt vmcnt(1)
    v_mov_b32 v4, 0
    v_mov_b32 v5, 0
    v_dot2_f32_bf16 v4, v40, v2, v4
    v_dot2_f32_bf16 v5, v40, v40, v5
    v_dot2_f32_bf16 v4, v41, v2, v4
    v_dot2_f32_bf16 v5, v41, v41, v5
    v_dot2_f32_bf16 v4, v42, v2, v4
    v_dot2_f32_bf16 v5, v42, v42, v5
    v_dot2_f32_bf16 v4, v43, v2, v4
    v_dot2_f32_bf16 v5, v43, v43, v5
    s_nop 2
    ds_write_b32 v3, v4 offset:1536
    ds_write_b32 v3, v5 offset:3584
    s_waitcnt vmcnt(0)
    v_mov_b32 v4, 0
    v_mov_b32 v5, 0
    v_dot2_f32_bf16 v4, v44, v2, v4
    v_dot2_f32_bf16 v5, v44, v44, v5
    v_dot2_f32_bf16 v4, v45, v2, v4
    v_dot2_f32_bf16 v5, v45, v45, v5
    v_dot2_f32_bf16 v4, v46, v2, v4
    v_dot2_f32_bf16 v5, v46, v46, v5
    v_dot2_f32_bf16 v4, v47, v2, v4
    v_dot2_f32_bf16 v5, v47, v47, v5
    s_nop 2
    ds_write_b32 v3, v4 offset:1792
    ds_write_b32 v3, v5 offset:3840
    v_lshrrev_b32 v4, 3, v0
    v_lshlrev_b32 v4, 8, v4
    v_and_b32 v5, 7, v0
    v_lshl_add_u32 v4, v5, 5, v4
    v_add_u32 v4, s60, v4
    s_waitcnt lgkmcnt(0)
    ds_read_b128 v[16:19], v4 offset:0
    ds_read_b128 v[20:23], v4 offset:16
    ds_read_b128 v[24:27], v4 offset:2048
    ds_read_b128 v[28:31], v4 offset:2064
    s_waitcnt lgkmcnt(0)
    v_add_f32 v16, v16, v20
    v_add_f32 v17, v17, v21
    v_add_f32 v18, v18, v22
    v_add_f32 v19, v19, v23
    v_add_f32 v16, v16, v18
    v_add_f32 v17, v17, v19
    v_add_f32 v16, v16, v17
    v_add_f32 v24, v24, v28
    v_add_f32 v25, v25, v29
    v_add_f32 v26, v26, v30
    v_add_f32 v27, v27, v31
    v_add_f32 v24, v24, v26
    v_add_f32 v25, v25, v27
    v_add_f32 v24, v24, v25
    s_nop 1
    v_add_f32_dpp v16, v16, v16 quad_perm:[1,0,3,2] row_mask:0xf bank_mask:0xf
    v_add_f32_dpp v24, v24, v24 quad_perm:[1,0,3,2] row_mask:0xf bank_mask:0xf
    s_nop 1
    v_add_f32_dpp v16, v16, v16 quad_perm:[2,3,0,1] row_mask:0xf bank_mask:0xf
    v_add_f32_dpp v24, v24, v24 quad_perm:[2,3,0,1] row_mask:0xf bank_mask:0xf
    s_nop 1
    v_add_f32_dpp v16, v16, v16 row_half_mirror row_mask:0xf bank_mask:0xf
    v_add_f32_dpp v24, v24, v24 row_half_mirror row_mask:0xf bank_mask:0xf
    v_mul_f32 v16, 0x3b000000, v16
    v_mul_f32 v24, 0x3b000000, v24
    v_fma_f32 v24, -v16, v16, v24
    v_max_f32 v24, 0, v24
    v_cvt_pk_bf16_f32 v11, v24, v24
    v_and_b32 v11, 0xffff0000, v11
    v_add_f32 v11, 0x3727c5ac, v11
    v_cvt_pk_bf16_f32 v11, v11, v11
    v_and_b32 v11, 0xffff0000, v11
    v_sqrt_f32 v11, v11
    v_sub_f32 v16, 0, v16
    v_cvt_pk_bf16_f32 v49, v11, 0
    v_cvt_pk_bf16_f32 v48, v16, v16
    v_lshlrev_b32 v11, 16, v49
    v_rcp_f32 v50, v11
    v_mov_b32 v51, 0
    v_lshrrev_b32 v12, 3, v0
    v_lshlrev_b32 v13, 4, v12
    v_lshlrev_b32 v14, 2, v12
    s_lshl_b32 s59, s56, 4
    s_add_u32 s59, s59, 18874368
    s_lshl_b32 s60, s56, 2
    s_add_u32 s60, s60, 18907136
    v_and_b32 v10, 7, v0
    v_cmp_eq_u32 vcc, 0, v10
    s_and_saveexec_b64 s[62:63], vcc
    buffer_store_dwordx4 v[48:51], v13, s[24:27], s59 offen sc1
    buffer_store_dword v50, v14, s[24:27], s60 offen sc1
    s_mov_b64 exec, s[62:63]
    s_cmp_lg_u32 s56, 0
    s_cbranch_scc1 parallel_rs0
    v_mov_b32 v12, 0
    v_lshlrev_b32 v13, 7, v0
    s_mov_b32 s59, 18931712
    buffer_store_dword v12, v13, s[24:27], s59 offen sc1
    s_add_u32 s59, s59, 8192
    buffer_store_dword v12, v13, s[24:27], s59 offen sc1
    s_add_u32 s59, s59, 8192
    buffer_store_dword v12, v13, s[24:27], s59 offen sc1
    s_add_u32 s59, s59, 8192
parallel_rs0:
    s_barrier
    s_barrier
    s_waitcnt vmcnt(0)
    v_mov_b32 v1, 155696
    v_mov_b32 v2, 1
    s_mov_b64 exec, 1
    ds_add_rtn_u32 v3, v1, v2
    s_mov_b64 exec, -1
    s_waitcnt lgkmcnt(0)
    v_readfirstlane_b32 s58, v3
    s_nop 3
    s_cmp_lg_u32 s58, 1
    s_cbranch_scc1 parallel_rs1
    v_mov_b32 v3, 0
    s_lshl_b32 s58, s44, 2
    v_mov_b32 v2, 1
    s_mov_b64 exec, 0x1
    buffer_atomic_add v2, v3, s[32:35], s58 offen sc1
    s_mov_b64 exec, -1
parallel_rs1:
    s_barrier
    s_barrier
    s_barrier
    s_barrier
    s_barrier
    s_barrier
    s_branch parallel_p2attn
parallel_loader:
    s_sub_u32 s41, s86, 8
    s_cmp_lt_u32 s43, 6
    s_cbranch_scc1 parallel_loaderQ
    s_cmp_lt_u32 s43, 6
    s_mov_b32 s58, 3584
    s_cselect_b32 s57, 3072, s58
    s_cselect_b32 s58, 0, 6
    s_sub_u32 s46, s43, s58
    s_lshl_b32 s46, s46, 8
    s_lshl_b32 s47, s57, 3
    v_lshrrev_b32 v1, 3, v0
    v_and_b32 v2, 7, v0
    v_lshrrev_b32 v3, 4, v0
    v_xor_b32 v4, v2, v3
    v_lshlrev_b32 v4, 4, v4
    v_lshl_add_u32 v8, v1, 10, v4
    v_xor_b32 v9, 64, v8
    v_and_b32 v4, 1, v3
    v_lshlrev_b32 v4, 2, v4
    v_xor_b32 v4, v2, v4
    v_lshlrev_b32 v4, 4, v4
    v_mul_lo_u32 v10, s57, v1
    v_add_u32 v10, v10, v4
    s_lshl_b32 s48, s41, 15
    s_lshl_b32 s58, s41, 6
    s_add_u32 s58, s58, s46
    s_lshl_b32 s49, s58, 1
    s_lshl_b32 s50, s41, 12
    s_lshl_b32 s51, s41, 13
    s_add_u32 s51, s51, 16384
    s_lshl_b32 s58, s43, 1
    s_add_u32 s58, s58, 15
    v_add_u32 v12, s58, v0
    v_mov_b32 v1, s44
    v_cmp_eq_u32 vcc, 0, v0
    s_nop 1
    v_cndmask_b32 v12, v12, v1, vcc
    v_cmp_lt_u32 vcc, 2, v0
    s_nop 1
    v_cndmask_b32 v12, v12, 0, vcc
    v_lshlrev_b32 v12, 2, v12
    v_subrev_u32 v1, 1, v0
    v_cmp_gt_u32 vcc, 2, v1
    v_mov_b32 v2, 8
    s_nop 0
    v_cndmask_b32 v14, v2, 1, vcc
    s_waitcnt lgkmcnt(0)
    s_lshl_b32 s58, s44, 17
    s_add_u32 s4, s64, s58
    s_addc_u32 s5, s65, 0
    s_mov_b32 s16, s4
    s_mov_b32 s17, s5
    s_mov_b32 s18, 131072
    s_mov_b32 s19, 0x20000
    s_cmp_lt_u32 s43, 6
    s_cselect_b32 s20, s66, s72
    s_cselect_b32 s21, s67, s73
    s_lshl_b32 s22, s57, 9
    s_mov_b32 s23, 0x20000
    s_add_u32 m0, s50, 0
    s_add_u32 s58, s48, 0
    buffer_load_dwordx4 v8, s[16:19], s58 offen lds
    s_add_u32 m0, s50, 1024
    s_add_u32 s58, s48, 8192
    buffer_load_dwordx4 v9, s[16:19], s58 offen lds
    s_add_u32 m0, s50, 2048
    s_add_u32 s58, s48, 16384
    buffer_load_dwordx4 v8, s[16:19], s58 offen lds
    s_add_u32 m0, s50, 3072
    s_add_u32 s58, s48, 24576
    buffer_load_dwordx4 v9, s[16:19], s58 offen lds
    s_add_u32 m0, s51, 0
    s_nop 0
    buffer_load_dwordx4 v10, s[20:23], s49 offen lds
    s_add_u32 s49, s49, s47
    s_add_u32 m0, s51, 1024
    s_nop 0
    buffer_load_dwordx4 v10, s[20:23], s49 offen lds
    s_add_u32 s49, s49, s47
    s_add_u32 m0, s51, 2048
    s_nop 0
    buffer_load_dwordx4 v10, s[20:23], s49 offen lds
    s_add_u32 s49, s49, s47
    s_add_u32 m0, s51, 3072
    s_nop 0
    buffer_load_dwordx4 v10, s[20:23], s49 offen lds
    s_add_u32 s49, s49, s47
    s_add_u32 m0, s51, 4096
    s_nop 0
    buffer_load_dwordx4 v10, s[20:23], s49 offen lds
    s_add_u32 s49, s49, s47
    s_add_u32 m0, s51, 5120
    s_nop 0
    buffer_load_dwordx4 v10, s[20:23], s49 offen lds
    s_add_u32 s49, s49, s47
    s_add_u32 m0, s51, 6144
    s_nop 0
    buffer_load_dwordx4 v10, s[20:23], s49 offen lds
    s_add_u32 s49, s49, s47
    s_add_u32 m0, s51, 7168
    s_nop 0
    buffer_load_dwordx4 v10, s[20:23], s49 offen lds
    s_add_u32 s49, s49, s47
    s_add_u32 m0, s50, 49152
    s_add_u32 s58, s48, 128
    buffer_load_dwordx4 v8, s[16:19], s58 offen lds
    s_add_u32 m0, s50, 50176
    s_add_u32 s58, s48, 8320
    buffer_load_dwordx4 v9, s[16:19], s58 offen lds
    s_add_u32 m0, s50, 51200
    s_add_u32 s58, s48, 16512
    buffer_load_dwordx4 v8, s[16:19], s58 offen lds
    s_add_u32 m0, s50, 52224
    s_add_u32 s58, s48, 24704
    buffer_load_dwordx4 v9, s[16:19], s58 offen lds
    s_add_u32 m0, s51, 49152
    s_nop 0
    buffer_load_dwordx4 v10, s[20:23], s49 offen lds
    s_add_u32 s49, s49, s47
    s_add_u32 m0, s51, 50176
    s_nop 0
    buffer_load_dwordx4 v10, s[20:23], s49 offen lds
    s_add_u32 s49, s49, s47
    s_add_u32 m0, s51, 51200
    s_nop 0
    buffer_load_dwordx4 v10, s[20:23], s49 offen lds
    s_add_u32 s49, s49, s47
    s_add_u32 m0, s51, 52224
    s_nop 0
    buffer_load_dwordx4 v10, s[20:23], s49 offen lds
    s_add_u32 s49, s49, s47
    s_add_u32 m0, s51, 53248
    s_nop 0
    buffer_load_dwordx4 v10, s[20:23], s49 offen lds
    s_add_u32 s49, s49, s47
    s_add_u32 m0, s51, 54272
    s_nop 0
    buffer_load_dwordx4 v10, s[20:23], s49 offen lds
    s_add_u32 s49, s49, s47
    s_add_u32 m0, s51, 55296
    s_nop 0
    buffer_load_dwordx4 v10, s[20:23], s49 offen lds
    s_add_u32 s49, s49, s47
    s_add_u32 m0, s51, 56320
    s_nop 0
    buffer_load_dwordx4 v10, s[20:23], s49 offen lds
    s_add_u32 s49, s49, s47
    v_mov_b32 v1, 0
    v_lshlrev_b32 v2, 2, v0
    v_add_u32 v2, 155648, v2
    ds_write_b32 v2, v1
    s_waitcnt lgkmcnt(0)
    s_mov_b32 s32, s82
    s_mov_b32 s33, s83
    s_mov_b32 s34, 256
    s_mov_b32 s35, 0x20000
    s_waitcnt vmcnt(12)
    s_barrier
    s_add_u32 m0, s50, 98304
    s_add_u32 s58, s48, 256
    buffer_load_dwordx4 v8, s[16:19], s58 offen lds
    s_add_u32 m0, s50, 99328
    s_add_u32 s58, s48, 8448
    buffer_load_dwordx4 v9, s[16:19], s58 offen lds
    s_add_u32 m0, s50, 100352
    s_add_u32 s58, s48, 16640
    buffer_load_dwordx4 v8, s[16:19], s58 offen lds
    s_add_u32 m0, s50, 101376
    s_add_u32 s58, s48, 24832
    buffer_load_dwordx4 v9, s[16:19], s58 offen lds
    s_add_u32 m0, s51, 98304
    s_nop 0
    buffer_load_dwordx4 v10, s[20:23], s49 offen lds
    s_add_u32 s49, s49, s47
    s_add_u32 m0, s51, 99328
    s_nop 0
    buffer_load_dwordx4 v10, s[20:23], s49 offen lds
    s_add_u32 s49, s49, s47
    s_add_u32 m0, s51, 100352
    s_nop 0
    buffer_load_dwordx4 v10, s[20:23], s49 offen lds
    s_add_u32 s49, s49, s47
    s_add_u32 m0, s51, 101376
    s_nop 0
    buffer_load_dwordx4 v10, s[20:23], s49 offen lds
    s_add_u32 s49, s49, s47
    s_add_u32 m0, s51, 102400
    s_nop 0
    buffer_load_dwordx4 v10, s[20:23], s49 offen lds
    s_add_u32 s49, s49, s47
    s_add_u32 m0, s51, 103424
    s_nop 0
    buffer_load_dwordx4 v10, s[20:23], s49 offen lds
    s_add_u32 s49, s49, s47
    s_add_u32 m0, s51, 104448
    s_nop 0
    buffer_load_dwordx4 v10, s[20:23], s49 offen lds
    s_add_u32 s49, s49, s47
    s_add_u32 m0, s51, 105472
    s_nop 0
    buffer_load_dwordx4 v10, s[20:23], s49 offen lds
    s_add_u32 s49, s49, s47
    s_waitcnt vmcnt(12)
    s_barrier
    s_add_u32 m0, s50, 0
    s_add_u32 s58, s48, 384
    buffer_load_dwordx4 v8, s[16:19], s58 offen lds
    s_add_u32 m0, s50, 1024
    s_add_u32 s58, s48, 8576
    buffer_load_dwordx4 v9, s[16:19], s58 offen lds
    s_add_u32 m0, s50, 2048
    s_add_u32 s58, s48, 16768
    buffer_load_dwordx4 v8, s[16:19], s58 offen lds
    s_add_u32 m0, s50, 3072
    s_add_u32 s58, s48, 24960
    buffer_load_dwordx4 v9, s[16:19], s58 offen lds
    s_add_u32 m0, s51, 0
    s_nop 0
    buffer_load_dwordx4 v10, s[20:23], s49 offen lds
    s_add_u32 s49, s49, s47
    s_add_u32 m0, s51, 1024
    s_nop 0
    buffer_load_dwordx4 v10, s[20:23], s49 offen lds
    s_add_u32 s49, s49, s47
    s_add_u32 m0, s51, 2048
    s_nop 0
    buffer_load_dwordx4 v10, s[20:23], s49 offen lds
    s_add_u32 s49, s49, s47
    s_add_u32 m0, s51, 3072
    s_nop 0
    buffer_load_dwordx4 v10, s[20:23], s49 offen lds
    s_add_u32 s49, s49, s47
    s_add_u32 m0, s51, 4096
    s_nop 0
    buffer_load_dwordx4 v10, s[20:23], s49 offen lds
    s_add_u32 s49, s49, s47
    s_add_u32 m0, s51, 5120
    s_nop 0
    buffer_load_dwordx4 v10, s[20:23], s49 offen lds
    s_add_u32 s49, s49, s47
    s_add_u32 m0, s51, 6144
    s_nop 0
    buffer_load_dwordx4 v10, s[20:23], s49 offen lds
    s_add_u32 s49, s49, s47
    s_add_u32 m0, s51, 7168
    s_nop 0
    buffer_load_dwordx4 v10, s[20:23], s49 offen lds
    s_add_u32 s49, s49, s47
    s_waitcnt vmcnt(12)
    s_barrier
    s_add_u32 m0, s50, 49152
    s_add_u32 s58, s48, 512
    buffer_load_dwordx4 v8, s[16:19], s58 offen lds
    s_add_u32 m0, s50, 50176
    s_add_u32 s58, s48, 8704
    buffer_load_dwordx4 v9, s[16:19], s58 offen lds
    s_add_u32 m0, s50, 51200
    s_add_u32 s58, s48, 16896
    buffer_load_dwordx4 v8, s[16:19], s58 offen lds
    s_add_u32 m0, s50, 52224
    s_add_u32 s58, s48, 25088
    buffer_load_dwordx4 v9, s[16:19], s58 offen lds
    s_add_u32 m0, s51, 49152
    s_nop 0
    buffer_load_dwordx4 v10, s[20:23], s49 offen lds
    s_add_u32 s49, s49, s47
    s_add_u32 m0, s51, 50176
    s_nop 0
    buffer_load_dwordx4 v10, s[20:23], s49 offen lds
    s_add_u32 s49, s49, s47
    s_add_u32 m0, s51, 51200
    s_nop 0
    buffer_load_dwordx4 v10, s[20:23], s49 offen lds
    s_add_u32 s49, s49, s47
    s_add_u32 m0, s51, 52224
    s_nop 0
    buffer_load_dwordx4 v10, s[20:23], s49 offen lds
    s_add_u32 s49, s49, s47
    s_add_u32 m0, s51, 53248
    s_nop 0
    buffer_load_dwordx4 v10, s[20:23], s49 offen lds
    s_add_u32 s49, s49, s47
    s_add_u32 m0, s51, 54272
    s_nop 0
    buffer_load_dwordx4 v10, s[20:23], s49 offen lds
    s_add_u32 s49, s49, s47
    s_add_u32 m0, s51, 55296
    s_nop 0
    buffer_load_dwordx4 v10, s[20:23], s49 offen lds
    s_add_u32 s49, s49, s47
    s_add_u32 m0, s51, 56320
    s_nop 0
    buffer_load_dwordx4 v10, s[20:23], s49 offen lds
    s_add_u32 s49, s49, s47
    s_waitcnt vmcnt(12)
    s_barrier
    s_add_u32 m0, s50, 98304
    s_add_u32 s58, s48, 640
    buffer_load_dwordx4 v8, s[16:19], s58 offen lds
    s_add_u32 m0, s50, 99328
    s_add_u32 s58, s48, 8832
    buffer_load_dwordx4 v9, s[16:19], s58 offen lds
    s_add_u32 m0, s50, 100352
    s_add_u32 s58, s48, 17024
    buffer_load_dwordx4 v8, s[16:19], s58 offen lds
    s_add_u32 m0, s50, 101376
    s_add_u32 s58, s48, 25216
    buffer_load_dwordx4 v9, s[16:19], s58 offen lds
    s_add_u32 m0, s51, 98304
    s_nop 0
    buffer_load_dwordx4 v10, s[20:23], s49 offen lds
    s_add_u32 s49, s49, s47
    s_add_u32 m0, s51, 99328
    s_nop 0
    buffer_load_dwordx4 v10, s[20:23], s49 offen lds
    s_add_u32 s49, s49, s47
    s_add_u32 m0, s51, 100352
    s_nop 0
    buffer_load_dwordx4 v10, s[20:23], s49 offen lds
    s_add_u32 s49, s49, s47
    s_add_u32 m0, s51, 101376
    s_nop 0
    buffer_load_dwordx4 v10, s[20:23], s49 offen lds
    s_add_u32 s49, s49, s47
    s_add_u32 m0, s51, 102400
    s_nop 0
    buffer_load_dwordx4 v10, s[20:23], s49 offen lds
    s_add_u32 s49, s49, s47
    s_add_u32 m0, s51, 103424
    s_nop 0
    buffer_load_dwordx4 v10, s[20:23], s49 offen lds
    s_add_u32 s49, s49, s47
    s_add_u32 m0, s51, 104448
    s_nop 0
    buffer_load_dwordx4 v10, s[20:23], s49 offen lds
    s_add_u32 s49, s49, s47
    s_add_u32 m0, s51, 105472
    s_nop 0
    buffer_load_dwordx4 v10, s[20:23], s49 offen lds
    s_add_u32 s49, s49, s47
    s_waitcnt vmcnt(12)
    s_barrier
    s_add_u32 m0, s50, 0
    s_add_u32 s58, s48, 768
    buffer_load_dwordx4 v8, s[16:19], s58 offen lds
    s_add_u32 m0, s50, 1024
    s_add_u32 s58, s48, 8960
    buffer_load_dwordx4 v9, s[16:19], s58 offen lds
    s_add_u32 m0, s50, 2048
    s_add_u32 s58, s48, 17152
    buffer_load_dwordx4 v8, s[16:19], s58 offen lds
    s_add_u32 m0, s50, 3072
    s_add_u32 s58, s48, 25344
    buffer_load_dwordx4 v9, s[16:19], s58 offen lds
    s_add_u32 m0, s51, 0
    s_nop 0
    buffer_load_dwordx4 v10, s[20:23], s49 offen lds
    s_add_u32 s49, s49, s47
    s_add_u32 m0, s51, 1024
    s_nop 0
    buffer_load_dwordx4 v10, s[20:23], s49 offen lds
    s_add_u32 s49, s49, s47
    s_add_u32 m0, s51, 2048
    s_nop 0
    buffer_load_dwordx4 v10, s[20:23], s49 offen lds
    s_add_u32 s49, s49, s47
    s_add_u32 m0, s51, 3072
    s_nop 0
    buffer_load_dwordx4 v10, s[20:23], s49 offen lds
    s_add_u32 s49, s49, s47
    s_add_u32 m0, s51, 4096
    s_nop 0
    buffer_load_dwordx4 v10, s[20:23], s49 offen lds
    s_add_u32 s49, s49, s47
    s_add_u32 m0, s51, 5120
    s_nop 0
    buffer_load_dwordx4 v10, s[20:23], s49 offen lds
    s_add_u32 s49, s49, s47
    s_add_u32 m0, s51, 6144
    s_nop 0
    buffer_load_dwordx4 v10, s[20:23], s49 offen lds
    s_add_u32 s49, s49, s47
    s_add_u32 m0, s51, 7168
    s_nop 0
    buffer_load_dwordx4 v10, s[20:23], s49 offen lds
    s_add_u32 s49, s49, s47
    s_waitcnt vmcnt(12)
    s_barrier
    s_add_u32 m0, s50, 49152
    s_add_u32 s58, s48, 896
    buffer_load_dwordx4 v8, s[16:19], s58 offen lds
    s_add_u32 m0, s50, 50176
    s_add_u32 s58, s48, 9088
    buffer_load_dwordx4 v9, s[16:19], s58 offen lds
    s_add_u32 m0, s50, 51200
    s_add_u32 s58, s48, 17280
    buffer_load_dwordx4 v8, s[16:19], s58 offen lds
    s_add_u32 m0, s50, 52224
    s_add_u32 s58, s48, 25472
    buffer_load_dwordx4 v9, s[16:19], s58 offen lds
    s_add_u32 m0, s51, 49152
    s_nop 0
    buffer_load_dwordx4 v10, s[20:23], s49 offen lds
    s_add_u32 s49, s49, s47
    s_add_u32 m0, s51, 50176
    s_nop 0
    buffer_load_dwordx4 v10, s[20:23], s49 offen lds
    s_add_u32 s49, s49, s47
    s_add_u32 m0, s51, 51200
    s_nop 0
    buffer_load_dwordx4 v10, s[20:23], s49 offen lds
    s_add_u32 s49, s49, s47
    s_add_u32 m0, s51, 52224
    s_nop 0
    buffer_load_dwordx4 v10, s[20:23], s49 offen lds
    s_add_u32 s49, s49, s47
    s_add_u32 m0, s51, 53248
    s_nop 0
    buffer_load_dwordx4 v10, s[20:23], s49 offen lds
    s_add_u32 s49, s49, s47
    s_add_u32 m0, s51, 54272
    s_nop 0
    buffer_load_dwordx4 v10, s[20:23], s49 offen lds
    s_add_u32 s49, s49, s47
    s_add_u32 m0, s51, 55296
    s_nop 0
    buffer_load_dwordx4 v10, s[20:23], s49 offen lds
    s_add_u32 s49, s49, s47
    s_add_u32 m0, s51, 56320
    s_nop 0
    buffer_load_dwordx4 v10, s[20:23], s49 offen lds
    s_add_u32 s49, s49, s47
    s_waitcnt vmcnt(12)
    s_barrier
    s_waitcnt vmcnt(0)
    s_cmp_lg_u32 s86, 8
    s_cbranch_scc1 parallel_ok_2
parallel_poll_1:
    buffer_load_dword v13, v12, s[32:35], 0 offen sc1
    s_waitcnt vmcnt(0)
    v_cmp_ge_u32 vcc, v13, v14
    s_nop 3
    s_and_b32 s58, vcc_lo, 15
    s_cmp_eq_u32 s58, 15
    s_cbranch_scc1 parallel_ok_2
    s_sleep 8
    s_branch parallel_poll_1
parallel_ok_2:
    s_barrier
    s_barrier
    s_cmp_lg_u32 s86, 8
    s_cbranch_scc1 parallel_p2gemm_poll
    s_add_u32 s32, s84, 18931712
    s_addc_u32 s33, s85, 0
    s_mov_b32 s34, 24576
    s_mov_b32 s35, 0x20000
    v_lshlrev_b32 v3, 7, v0
    s_cmp_lt_u32 s43, 6
    s_cbranch_scc0 parallel_p2gemm_poll
    s_and_b32 s58, s43, 1
    s_mul_i32 s58, s58, 4096
    v_mov_b32 v2, 1
    s_mov_b64 exec, 0xffffffff
    buffer_atomic_add v2, v3, s[32:35], s58 offen sc1
    s_mov_b64 exec, -1
    s_branch parallel_p2gemm_poll
parallel_sigH:
    s_lshl_b32 s58, s44, 8
    s_add_u32 s58, s58, 8192
    v_mov_b32 v2, 1
    s_mov_b64 exec, 0x3
    buffer_atomic_add v2, v3, s[32:35], s58 offen sc1
    s_mov_b64 exec, -1
    s_branch parallel_p2gemm_poll
parallel_loaderQ:
    v_lshrrev_b32 v1, 3, v0
    v_and_b32 v2, 7, v0
    v_lshrrev_b32 v3, 4, v0
    v_xor_b32 v4, v2, v3
    v_lshlrev_b32 v4, 4, v4
    v_lshl_add_u32 v8, v1, 10, v4
    v_xor_b32 v9, 64, v8
    v_and_b32 v4, 1, v3
    v_lshlrev_b32 v4, 2, v4
    v_xor_b32 v4, v2, v4
    v_lshlrev_b32 v4, 4, v4
    v_mul_u32_u24 v10, 3072, v1
    v_add_u32 v10, v10, v4
    s_lshl_b32 s48, s41, 15
    s_lshl_b32 s50, s41, 12
    s_mul_i32 s57, s41, 6
    s_add_u32 s58, s57, 0
    s_lshr_b32 s59, s58, 3
    s_and_b32 s58, s58, 7
    s_mul_i32 s24, s58, 24576
    s_lshl_b32 s60, s59, 10
    s_add_u32 s24, s24, s60
    s_lshl_b32 s60, s45, 7
    s_add_u32 s24, s24, s60
    s_lshl_b32 s59, s59, 13
    s_lshl_b32 s58, s58, 10
    s_add_u32 s30, s59, s58
    s_add_u32 s30, s30, 16384
    s_add_u32 s58, s57, 1
    s_lshr_b32 s59, s58, 3
    s_and_b32 s58, s58, 7
    s_mul_i32 s25, s58, 24576
    s_lshl_b32 s60, s59, 10
    s_add_u32 s25, s25, s60
    s_lshl_b32 s60, s45, 7
    s_add_u32 s25, s25, s60
    s_lshl_b32 s59, s59, 13
    s_lshl_b32 s58, s58, 10
    s_add_u32 s31, s59, s58
    s_add_u32 s31, s31, 16384
    s_add_u32 s58, s57, 2
    s_lshr_b32 s59, s58, 3
    s_and_b32 s58, s58, 7
    s_mul_i32 s26, s58, 24576
    s_lshl_b32 s60, s59, 10
    s_add_u32 s26, s26, s60
    s_lshl_b32 s60, s45, 7
    s_add_u32 s26, s26, s60
    s_lshl_b32 s59, s59, 13
    s_lshl_b32 s58, s58, 10
    s_add_u32 s36, s59, s58
    s_add_u32 s36, s36, 16384
    s_add_u32 s58, s57, 3
    s_lshr_b32 s59, s58, 3
    s_and_b32 s58, s58, 7
    s_mul_i32 s27, s58, 24576
    s_lshl_b32 s60, s59, 10
    s_add_u32 s27, s27, s60
    s_lshl_b32 s60, s45, 7
    s_add_u32 s27, s27, s60
    s_lshl_b32 s59, s59, 13
    s_lshl_b32 s58, s58, 10
    s_add_u32 s37, s59, s58
    s_add_u32 s37, s37, 16384
    s_add_u32 s58, s57, 4
    s_lshr_b32 s59, s58, 3
    s_and_b32 s58, s58, 7
    s_mul_i32 s28, s58, 24576
    s_lshl_b32 s60, s59, 10
    s_add_u32 s28, s28, s60
    s_lshl_b32 s60, s45, 7
    s_add_u32 s28, s28, s60
    s_lshl_b32 s59, s59, 13
    s_lshl_b32 s58, s58, 10
    s_add_u32 s38, s59, s58
    s_add_u32 s38, s38, 16384
    s_add_u32 s58, s57, 5
    s_lshr_b32 s59, s58, 3
    s_and_b32 s58, s58, 7
    s_mul_i32 s29, s58, 24576
    s_lshl_b32 s60, s59, 10
    s_add_u32 s29, s29, s60
    s_lshl_b32 s60, s45, 7
    s_add_u32 s29, s29, s60
    s_lshl_b32 s59, s59, 13
    s_lshl_b32 s58, s58, 10
    s_add_u32 s39, s59, s58
    s_add_u32 s39, s39, 16384
    s_lshr_b32 s58, s45, 1
    s_add_u32 s58, s58, 12
    v_lshlrev_b32 v12, 2, v0
    v_add_u32 v12, s58, v12
    v_mov_b32 v1, s44
    v_cmp_eq_u32 vcc, 0, v0
    s_nop 1
    v_cndmask_b32 v12, v12, v1, vcc
    v_cmp_lt_u32 vcc, 3, v0
    s_nop 1
    v_cndmask_b32 v12, v12, 0, vcc
    v_lshlrev_b32 v12, 2, v12
    v_subrev_u32 v1, 1, v0
    v_cmp_gt_u32 vcc, 3, v1
    v_mov_b32 v2, 8
    s_nop 0
    v_cndmask_b32 v14, v2, 1, vcc
    s_waitcnt lgkmcnt(0)
    s_lshl_b32 s58, s44, 17
    s_add_u32 s4, s64, s58
    s_addc_u32 s5, s65, 0
    s_mov_b32 s16, s4
    s_mov_b32 s17, s5
    s_mov_b32 s18, 131072
    s_mov_b32 s19, 0x20000
    s_mov_b32 s20, s66
    s_mov_b32 s21, s67
    s_mov_b32 s22, 1572864
    s_mov_b32 s23, 0x20000
    s_add_u32 m0, s50, 0
    s_add_u32 s58, s48, 0
    buffer_load_dwordx4 v8, s[16:19], s58 offen lds
    s_add_u32 m0, s50, 1024
    s_add_u32 s58, s48, 8192
    buffer_load_dwordx4 v9, s[16:19], s58 offen lds
    s_add_u32 m0, s50, 2048
    s_add_u32 s58, s48, 16384
    buffer_load_dwordx4 v8, s[16:19], s58 offen lds
    s_add_u32 m0, s50, 3072
    s_add_u32 s58, s48, 24576
    buffer_load_dwordx4 v9, s[16:19], s58 offen lds
    s_add_u32 m0, s30, 0
    s_add_u32 s58, s24, 0
    buffer_load_dwordx4 v10, s[20:23], s58 offen lds
    s_add_u32 m0, s31, 0
    s_add_u32 s58, s25, 0
    buffer_load_dwordx4 v10, s[20:23], s58 offen lds
    s_add_u32 m0, s36, 0
    s_add_u32 s58, s26, 0
    buffer_load_dwordx4 v10, s[20:23], s58 offen lds
    s_add_u32 m0, s37, 0
    s_add_u32 s58, s27, 0
    buffer_load_dwordx4 v10, s[20:23], s58 offen lds
    s_add_u32 m0, s38, 0
    s_add_u32 s58, s28, 0
    buffer_load_dwordx4 v10, s[20:23], s58 offen lds
    s_add_u32 m0, s39, 0
    s_add_u32 s58, s29, 0
    buffer_load_dwordx4 v10, s[20:23], s58 offen lds
    s_add_u32 m0, s50, 49152
    s_add_u32 s58, s48, 128
    buffer_load_dwordx4 v8, s[16:19], s58 offen lds
    s_add_u32 m0, s50, 50176
    s_add_u32 s58, s48, 8320
    buffer_load_dwordx4 v9, s[16:19], s58 offen lds
    s_add_u32 m0, s50, 51200
    s_add_u32 s58, s48, 16512
    buffer_load_dwordx4 v8, s[16:19], s58 offen lds
    s_add_u32 m0, s50, 52224
    s_add_u32 s58, s48, 24704
    buffer_load_dwordx4 v9, s[16:19], s58 offen lds
    s_add_u32 m0, s30, 49152
    s_add_u32 s58, s24, 196608
    buffer_load_dwordx4 v10, s[20:23], s58 offen lds
    s_add_u32 m0, s31, 49152
    s_add_u32 s58, s25, 196608
    buffer_load_dwordx4 v10, s[20:23], s58 offen lds
    s_add_u32 m0, s36, 49152
    s_add_u32 s58, s26, 196608
    buffer_load_dwordx4 v10, s[20:23], s58 offen lds
    s_add_u32 m0, s37, 49152
    s_add_u32 s58, s27, 196608
    buffer_load_dwordx4 v10, s[20:23], s58 offen lds
    s_add_u32 m0, s38, 49152
    s_add_u32 s58, s28, 196608
    buffer_load_dwordx4 v10, s[20:23], s58 offen lds
    s_add_u32 m0, s39, 49152
    s_add_u32 s58, s29, 196608
    buffer_load_dwordx4 v10, s[20:23], s58 offen lds
    v_mov_b32 v1, 0
    v_lshlrev_b32 v2, 2, v0
    v_add_u32 v2, 155648, v2
    ds_write_b32 v2, v1
    s_waitcnt lgkmcnt(0)
    s_mov_b32 s32, s82
    s_mov_b32 s33, s83
    s_mov_b32 s34, 256
    s_mov_b32 s35, 0x20000
    s_waitcnt vmcnt(10)
    s_barrier
    s_add_u32 m0, s50, 98304
    s_add_u32 s58, s48, 256
    buffer_load_dwordx4 v8, s[16:19], s58 offen lds
    s_add_u32 m0, s50, 99328
    s_add_u32 s58, s48, 8448
    buffer_load_dwordx4 v9, s[16:19], s58 offen lds
    s_add_u32 m0, s50, 100352
    s_add_u32 s58, s48, 16640
    buffer_load_dwordx4 v8, s[16:19], s58 offen lds
    s_add_u32 m0, s50, 101376
    s_add_u32 s58, s48, 24832
    buffer_load_dwordx4 v9, s[16:19], s58 offen lds
    s_add_u32 m0, s30, 98304
    s_add_u32 s58, s24, 393216
    buffer_load_dwordx4 v10, s[20:23], s58 offen lds
    s_add_u32 m0, s31, 98304
    s_add_u32 s58, s25, 393216
    buffer_load_dwordx4 v10, s[20:23], s58 offen lds
    s_add_u32 m0, s36, 98304
    s_add_u32 s58, s26, 393216
    buffer_load_dwordx4 v10, s[20:23], s58 offen lds
    s_add_u32 m0, s37, 98304
    s_add_u32 s58, s27, 393216
    buffer_load_dwordx4 v10, s[20:23], s58 offen lds
    s_add_u32 m0, s38, 98304
    s_add_u32 s58, s28, 393216
    buffer_load_dwordx4 v10, s[20:23], s58 offen lds
    s_add_u32 m0, s39, 98304
    s_add_u32 s58, s29, 393216
    buffer_load_dwordx4 v10, s[20:23], s58 offen lds
    s_waitcnt vmcnt(10)
    s_barrier
    s_add_u32 m0, s50, 0
    s_add_u32 s58, s48, 384
    buffer_load_dwordx4 v8, s[16:19], s58 offen lds
    s_add_u32 m0, s50, 1024
    s_add_u32 s58, s48, 8576
    buffer_load_dwordx4 v9, s[16:19], s58 offen lds
    s_add_u32 m0, s50, 2048
    s_add_u32 s58, s48, 16768
    buffer_load_dwordx4 v8, s[16:19], s58 offen lds
    s_add_u32 m0, s50, 3072
    s_add_u32 s58, s48, 24960
    buffer_load_dwordx4 v9, s[16:19], s58 offen lds
    s_add_u32 m0, s30, 0
    s_add_u32 s58, s24, 589824
    buffer_load_dwordx4 v10, s[20:23], s58 offen lds
    s_add_u32 m0, s31, 0
    s_add_u32 s58, s25, 589824
    buffer_load_dwordx4 v10, s[20:23], s58 offen lds
    s_add_u32 m0, s36, 0
    s_add_u32 s58, s26, 589824
    buffer_load_dwordx4 v10, s[20:23], s58 offen lds
    s_add_u32 m0, s37, 0
    s_add_u32 s58, s27, 589824
    buffer_load_dwordx4 v10, s[20:23], s58 offen lds
    s_add_u32 m0, s38, 0
    s_add_u32 s58, s28, 589824
    buffer_load_dwordx4 v10, s[20:23], s58 offen lds
    s_add_u32 m0, s39, 0
    s_add_u32 s58, s29, 589824
    buffer_load_dwordx4 v10, s[20:23], s58 offen lds
    s_waitcnt vmcnt(10)
    s_barrier
    s_add_u32 m0, s50, 49152
    s_add_u32 s58, s48, 512
    buffer_load_dwordx4 v8, s[16:19], s58 offen lds
    s_add_u32 m0, s50, 50176
    s_add_u32 s58, s48, 8704
    buffer_load_dwordx4 v9, s[16:19], s58 offen lds
    s_add_u32 m0, s50, 51200
    s_add_u32 s58, s48, 16896
    buffer_load_dwordx4 v8, s[16:19], s58 offen lds
    s_add_u32 m0, s50, 52224
    s_add_u32 s58, s48, 25088
    buffer_load_dwordx4 v9, s[16:19], s58 offen lds
    s_add_u32 m0, s30, 49152
    s_add_u32 s58, s24, 786432
    buffer_load_dwordx4 v10, s[20:23], s58 offen lds
    s_add_u32 m0, s31, 49152
    s_add_u32 s58, s25, 786432
    buffer_load_dwordx4 v10, s[20:23], s58 offen lds
    s_add_u32 m0, s36, 49152
    s_add_u32 s58, s26, 786432
    buffer_load_dwordx4 v10, s[20:23], s58 offen lds
    s_add_u32 m0, s37, 49152
    s_add_u32 s58, s27, 786432
    buffer_load_dwordx4 v10, s[20:23], s58 offen lds
    s_add_u32 m0, s38, 49152
    s_add_u32 s58, s28, 786432
    buffer_load_dwordx4 v10, s[20:23], s58 offen lds
    s_add_u32 m0, s39, 49152
    s_add_u32 s58, s29, 786432
    buffer_load_dwordx4 v10, s[20:23], s58 offen lds
    s_waitcnt vmcnt(10)
    s_barrier
    s_add_u32 m0, s50, 98304
    s_add_u32 s58, s48, 640
    buffer_load_dwordx4 v8, s[16:19], s58 offen lds
    s_add_u32 m0, s50, 99328
    s_add_u32 s58, s48, 8832
    buffer_load_dwordx4 v9, s[16:19], s58 offen lds
    s_add_u32 m0, s50, 100352
    s_add_u32 s58, s48, 17024
    buffer_load_dwordx4 v8, s[16:19], s58 offen lds
    s_add_u32 m0, s50, 101376
    s_add_u32 s58, s48, 25216
    buffer_load_dwordx4 v9, s[16:19], s58 offen lds
    s_add_u32 m0, s30, 98304
    s_add_u32 s58, s24, 983040
    buffer_load_dwordx4 v10, s[20:23], s58 offen lds
    s_add_u32 m0, s31, 98304
    s_add_u32 s58, s25, 983040
    buffer_load_dwordx4 v10, s[20:23], s58 offen lds
    s_add_u32 m0, s36, 98304
    s_add_u32 s58, s26, 983040
    buffer_load_dwordx4 v10, s[20:23], s58 offen lds
    s_add_u32 m0, s37, 98304
    s_add_u32 s58, s27, 983040
    buffer_load_dwordx4 v10, s[20:23], s58 offen lds
    s_add_u32 m0, s38, 98304
    s_add_u32 s58, s28, 983040
    buffer_load_dwordx4 v10, s[20:23], s58 offen lds
    s_add_u32 m0, s39, 98304
    s_add_u32 s58, s29, 983040
    buffer_load_dwordx4 v10, s[20:23], s58 offen lds
    s_waitcnt vmcnt(10)
    s_barrier
    s_add_u32 m0, s50, 0
    s_add_u32 s58, s48, 768
    buffer_load_dwordx4 v8, s[16:19], s58 offen lds
    s_add_u32 m0, s50, 1024
    s_add_u32 s58, s48, 8960
    buffer_load_dwordx4 v9, s[16:19], s58 offen lds
    s_add_u32 m0, s50, 2048
    s_add_u32 s58, s48, 17152
    buffer_load_dwordx4 v8, s[16:19], s58 offen lds
    s_add_u32 m0, s50, 3072
    s_add_u32 s58, s48, 25344
    buffer_load_dwordx4 v9, s[16:19], s58 offen lds
    s_add_u32 m0, s30, 0
    s_add_u32 s58, s24, 1179648
    buffer_load_dwordx4 v10, s[20:23], s58 offen lds
    s_add_u32 m0, s31, 0
    s_add_u32 s58, s25, 1179648
    buffer_load_dwordx4 v10, s[20:23], s58 offen lds
    s_add_u32 m0, s36, 0
    s_add_u32 s58, s26, 1179648
    buffer_load_dwordx4 v10, s[20:23], s58 offen lds
    s_add_u32 m0, s37, 0
    s_add_u32 s58, s27, 1179648
    buffer_load_dwordx4 v10, s[20:23], s58 offen lds
    s_add_u32 m0, s38, 0
    s_add_u32 s58, s28, 1179648
    buffer_load_dwordx4 v10, s[20:23], s58 offen lds
    s_add_u32 m0, s39, 0
    s_add_u32 s58, s29, 1179648
    buffer_load_dwordx4 v10, s[20:23], s58 offen lds
    s_waitcnt vmcnt(10)
    s_barrier
    s_add_u32 m0, s50, 49152
    s_add_u32 s58, s48, 896
    buffer_load_dwordx4 v8, s[16:19], s58 offen lds
    s_add_u32 m0, s50, 50176
    s_add_u32 s58, s48, 9088
    buffer_load_dwordx4 v9, s[16:19], s58 offen lds
    s_add_u32 m0, s50, 51200
    s_add_u32 s58, s48, 17280
    buffer_load_dwordx4 v8, s[16:19], s58 offen lds
    s_add_u32 m0, s50, 52224
    s_add_u32 s58, s48, 25472
    buffer_load_dwordx4 v9, s[16:19], s58 offen lds
    s_add_u32 m0, s30, 49152
    s_add_u32 s58, s24, 1376256
    buffer_load_dwordx4 v10, s[20:23], s58 offen lds
    s_add_u32 m0, s31, 49152
    s_add_u32 s58, s25, 1376256
    buffer_load_dwordx4 v10, s[20:23], s58 offen lds
    s_add_u32 m0, s36, 49152
    s_add_u32 s58, s26, 1376256
    buffer_load_dwordx4 v10, s[20:23], s58 offen lds
    s_add_u32 m0, s37, 49152
    s_add_u32 s58, s27, 1376256
    buffer_load_dwordx4 v10, s[20:23], s58 offen lds
    s_add_u32 m0, s38, 49152
    s_add_u32 s58, s28, 1376256
    buffer_load_dwordx4 v10, s[20:23], s58 offen lds
    s_add_u32 m0, s39, 49152
    s_add_u32 s58, s29, 1376256
    buffer_load_dwordx4 v10, s[20:23], s58 offen lds
    s_waitcnt vmcnt(10)
    s_barrier
    s_waitcnt vmcnt(0)
    s_cmp_lg_u32 s86, 8
    s_cbranch_scc1 parallel_ok_4
parallel_poll_3:
    buffer_load_dword v13, v12, s[32:35], 0 offen sc1
    s_waitcnt vmcnt(0)
    v_cmp_ge_u32 vcc, v13, v14
    s_nop 3
    s_and_b32 s58, vcc_lo, 31
    s_cmp_eq_u32 s58, 31
    s_cbranch_scc1 parallel_ok_4
    s_sleep 8
    s_branch parallel_poll_3
parallel_ok_4:
    s_barrier
    s_barrier
    s_cmp_lg_u32 s86, 8
    s_cbranch_scc1 parallel_p2gemm_poll
    s_add_u32 s32, s84, 18931712
    s_addc_u32 s33, s85, 0
    s_mov_b32 s34, 24576
    s_mov_b32 s35, 0x20000
    v_lshlrev_b32 v3, 7, v0
    s_lshr_b32 s58, s45, 2
    s_mul_i32 s58, s58, 4096
    v_mov_b32 v2, 1
    s_mov_b64 exec, 0xffffffff
    buffer_atomic_add v2, v3, s[32:35], s58 offen sc1
    s_mov_b64 exec, -1
    s_branch parallel_p2gemm_poll
parallel_helper:
    s_waitcnt lgkmcnt(0)
    s_mov_b32 s24, s84
    s_mov_b32 s25, s85
    s_mov_b32 s26, 18956288
    s_mov_b32 s27, 0x20000
    s_mov_b32 s32, s82
    s_mov_b32 s33, s83
    s_mov_b32 s34, 256
    s_mov_b32 s35, 0x20000
    s_mov_b32 s43, s96
    s_add_u32 s44, s96, 16
    s_cmp_ge_u32 s86, 8
    s_cbranch_scc1 parallel_hq1
    v_mov_b32 v5, 0x00003f80
    v_mov_b32 v6, 0x3f800000
    s_cmp_lt_u32 s43, 12
    s_mov_b32 s58, 3584
    s_cselect_b32 s57, 3072, s58
    s_cselect_b32 s16, s66, s72
    s_cselect_b32 s17, s67, s73
    s_cselect_b32 s58, 0, 12
    s_lshl_b32 s18, s57, 9
    s_mov_b32 s19, 0x20000
    s_sub_u32 s58, s43, s58
    s_lshl_b32 s58, s58, 8
    v_lshrrev_b32 v3, 4, v0
    v_mul_lo_u32 v3, s57, v3
    v_and_b32 v4, 15, v0
    v_lshl_add_u32 v3, v4, 4, v3
    s_mul_i32 s59, s57, s86
    s_lshl_b32 s59, s59, 2
    s_add_u32 s58, s58, s59
    s_lshl_b32 s59, s57, 5
    buffer_load_dwordx4 v[16:19], v3, s[16:19], s58 offen
    s_add_u32 s58, s58, s59
    buffer_load_dwordx4 v[20:23], v3, s[16:19], s58 offen
    s_add_u32 s58, s58, s59
    buffer_load_dwordx4 v[24:27], v3, s[16:19], s58 offen
    s_add_u32 s58, s58, s59
    buffer_load_dwordx4 v[28:31], v3, s[16:19], s58 offen
    s_add_u32 s58, s58, s59
    buffer_load_dwordx4 v[32:35], v3, s[16:19], s58 offen
    s_add_u32 s58, s58, s59
    buffer_load_dwordx4 v[36:39], v3, s[16:19], s58 offen
    s_add_u32 s58, s58, s59
    buffer_load_dwordx4 v[40:43], v3, s[16:19], s58 offen
    s_add_u32 s58, s58, s59
    buffer_load_dwordx4 v[44:47], v3, s[16:19], s58 offen
    s_add_u32 s58, s58, s59
    buffer_load_dwordx4 v[48:51], v3, s[16:19], s58 offen
    s_add_u32 s58, s58, s59
    buffer_load_dwordx4 v[52:55], v3, s[16:19], s58 offen
    s_add_u32 s58, s58, s59
    buffer_load_dwordx4 v[56:59], v3, s[16:19], s58 offen
    s_add_u32 s58, s58, s59
    buffer_load_dwordx4 v[60:63], v3, s[16:19], s58 offen
    s_add_u32 s58, s58, s59
    buffer_load_dwordx4 v[64:67], v3, s[16:19], s58 offen
    s_add_u32 s58, s58, s59
    buffer_load_dwordx4 v[68:71], v3, s[16:19], s58 offen
    s_add_u32 s58, s58, s59
    buffer_load_dwordx4 v[72:75], v3, s[16:19], s58 offen
    s_add_u32 s58, s58, s59
    buffer_load_dwordx4 v[76:79], v3, s[16:19], s58 offen
    s_add_u32 s58, s58, s59
    v_mov_b32 v144, 0
    v_mov_b32 v145, 0
    v_mov_b32 v146, 0
    v_mov_b32 v147, 0
    v_mov_b32 v148, 0
    v_mov_b32 v149, 0
    v_mov_b32 v150, 0
    v_mov_b32 v151, 0
    s_waitcnt vmcnt(15)
    v_dot2_f32_bf16 v144, v16, v5, v144
    v_dot2_f32_bf16 v145, v16, v6, v145
    v_dot2_f32_bf16 v146, v17, v5, v146
    v_dot2_f32_bf16 v147, v17, v6, v147
    v_dot2_f32_bf16 v148, v18, v5, v148
    v_dot2_f32_bf16 v149, v18, v6, v149
    v_dot2_f32_bf16 v150, v19, v5, v150
    v_dot2_f32_bf16 v151, v19, v6, v151
    s_waitcnt vmcnt(14)
    v_dot2_f32_bf16 v144, v20, v5, v144
    v_dot2_f32_bf16 v145, v20, v6, v145
    v_dot2_f32_bf16 v146, v21, v5, v146
    v_dot2_f32_bf16 v147, v21, v6, v147
    v_dot2_f32_bf16 v148, v22, v5, v148
    v_dot2_f32_bf16 v149, v22, v6, v149
    v_dot2_f32_bf16 v150, v23, v5, v150
    v_dot2_f32_bf16 v151, v23, v6, v151
    s_waitcnt vmcnt(13)
    v_dot2_f32_bf16 v144, v24, v5, v144
    v_dot2_f32_bf16 v145, v24, v6, v145
    v_dot2_f32_bf16 v146, v25, v5, v146
    v_dot2_f32_bf16 v147, v25, v6, v147
    v_dot2_f32_bf16 v148, v26, v5, v148
    v_dot2_f32_bf16 v149, v26, v6, v149
    v_dot2_f32_bf16 v150, v27, v5, v150
    v_dot2_f32_bf16 v151, v27, v6, v151
    s_waitcnt vmcnt(12)
    v_dot2_f32_bf16 v144, v28, v5, v144
    v_dot2_f32_bf16 v145, v28, v6, v145
    v_dot2_f32_bf16 v146, v29, v5, v146
    v_dot2_f32_bf16 v147, v29, v6, v147
    v_dot2_f32_bf16 v148, v30, v5, v148
    v_dot2_f32_bf16 v149, v30, v6, v149
    v_dot2_f32_bf16 v150, v31, v5, v150
    v_dot2_f32_bf16 v151, v31, v6, v151
    s_waitcnt vmcnt(11)
    v_dot2_f32_bf16 v144, v32, v5, v144
    v_dot2_f32_bf16 v145, v32, v6, v145
    v_dot2_f32_bf16 v146, v33, v5, v146
    v_dot2_f32_bf16 v147, v33, v6, v147
    v_dot2_f32_bf16 v148, v34, v5, v148
    v_dot2_f32_bf16 v149, v34, v6, v149
    v_dot2_f32_bf16 v150, v35, v5, v150
    v_dot2_f32_bf16 v151, v35, v6, v151
    s_waitcnt vmcnt(10)
    v_dot2_f32_bf16 v144, v36, v5, v144
    v_dot2_f32_bf16 v145, v36, v6, v145
    v_dot2_f32_bf16 v146, v37, v5, v146
    v_dot2_f32_bf16 v147, v37, v6, v147
    v_dot2_f32_bf16 v148, v38, v5, v148
    v_dot2_f32_bf16 v149, v38, v6, v149
    v_dot2_f32_bf16 v150, v39, v5, v150
    v_dot2_f32_bf16 v151, v39, v6, v151
    s_waitcnt vmcnt(9)
    v_dot2_f32_bf16 v144, v40, v5, v144
    v_dot2_f32_bf16 v145, v40, v6, v145
    v_dot2_f32_bf16 v146, v41, v5, v146
    v_dot2_f32_bf16 v147, v41, v6, v147
    v_dot2_f32_bf16 v148, v42, v5, v148
    v_dot2_f32_bf16 v149, v42, v6, v149
    v_dot2_f32_bf16 v150, v43, v5, v150
    v_dot2_f32_bf16 v151, v43, v6, v151
    s_waitcnt vmcnt(8)
    v_dot2_f32_bf16 v144, v44, v5, v144
    v_dot2_f32_bf16 v145, v44, v6, v145
    v_dot2_f32_bf16 v146, v45, v5, v146
    v_dot2_f32_bf16 v147, v45, v6, v147
    v_dot2_f32_bf16 v148, v46, v5, v148
    v_dot2_f32_bf16 v149, v46, v6, v149
    v_dot2_f32_bf16 v150, v47, v5, v150
    v_dot2_f32_bf16 v151, v47, v6, v151
    s_waitcnt vmcnt(7)
    v_dot2_f32_bf16 v144, v48, v5, v144
    v_dot2_f32_bf16 v145, v48, v6, v145
    v_dot2_f32_bf16 v146, v49, v5, v146
    v_dot2_f32_bf16 v147, v49, v6, v147
    v_dot2_f32_bf16 v148, v50, v5, v148
    v_dot2_f32_bf16 v149, v50, v6, v149
    v_dot2_f32_bf16 v150, v51, v5, v150
    v_dot2_f32_bf16 v151, v51, v6, v151
    s_waitcnt vmcnt(6)
    v_dot2_f32_bf16 v144, v52, v5, v144
    v_dot2_f32_bf16 v145, v52, v6, v145
    v_dot2_f32_bf16 v146, v53, v5, v146
    v_dot2_f32_bf16 v147, v53, v6, v147
    v_dot2_f32_bf16 v148, v54, v5, v148
    v_dot2_f32_bf16 v149, v54, v6, v149
    v_dot2_f32_bf16 v150, v55, v5, v150
    v_dot2_f32_bf16 v151, v55, v6, v151
    s_waitcnt vmcnt(5)
    v_dot2_f32_bf16 v144, v56, v5, v144
    v_dot2_f32_bf16 v145, v56, v6, v145
    v_dot2_f32_bf16 v146, v57, v5, v146
    v_dot2_f32_bf16 v147, v57, v6, v147
    v_dot2_f32_bf16 v148, v58, v5, v148
    v_dot2_f32_bf16 v149, v58, v6, v149
    v_dot2_f32_bf16 v150, v59, v5, v150
    v_dot2_f32_bf16 v151, v59, v6, v151
    s_waitcnt vmcnt(4)
    v_dot2_f32_bf16 v144, v60, v5, v144
    v_dot2_f32_bf16 v145, v60, v6, v145
    v_dot2_f32_bf16 v146, v61, v5, v146
    v_dot2_f32_bf16 v147, v61, v6, v147
    v_dot2_f32_bf16 v148, v62, v5, v148
    v_dot2_f32_bf16 v149, v62, v6, v149
    v_dot2_f32_bf16 v150, v63, v5, v150
    v_dot2_f32_bf16 v151, v63, v6, v151
    s_waitcnt vmcnt(3)
    v_dot2_f32_bf16 v144, v64, v5, v144
    v_dot2_f32_bf16 v145, v64, v6, v145
    v_dot2_f32_bf16 v146, v65, v5, v146
    v_dot2_f32_bf16 v147, v65, v6, v147
    v_dot2_f32_bf16 v148, v66, v5, v148
    v_dot2_f32_bf16 v149, v66, v6, v149
    v_dot2_f32_bf16 v150, v67, v5, v150
    v_dot2_f32_bf16 v151, v67, v6, v151
    s_waitcnt vmcnt(2)
    v_dot2_f32_bf16 v144, v68, v5, v144
    v_dot2_f32_bf16 v145, v68, v6, v145
    v_dot2_f32_bf16 v146, v69, v5, v146
    v_dot2_f32_bf16 v147, v69, v6, v147
    v_dot2_f32_bf16 v148, v70, v5, v148
    v_dot2_f32_bf16 v149, v70, v6, v149
    v_dot2_f32_bf16 v150, v71, v5, v150
    v_dot2_f32_bf16 v151, v71, v6, v151
    s_waitcnt vmcnt(1)
    v_dot2_f32_bf16 v144, v72, v5, v144
    v_dot2_f32_bf16 v145, v72, v6, v145
    v_dot2_f32_bf16 v146, v73, v5, v146
    v_dot2_f32_bf16 v147, v73, v6, v147
    v_dot2_f32_bf16 v148, v74, v5, v148
    v_dot2_f32_bf16 v149, v74, v6, v149
    v_dot2_f32_bf16 v150, v75, v5, v150
    v_dot2_f32_bf16 v151, v75, v6, v151
    s_waitcnt vmcnt(0)
    v_dot2_f32_bf16 v144, v76, v5, v144
    v_dot2_f32_bf16 v145, v76, v6, v145
    v_dot2_f32_bf16 v146, v77, v5, v146
    v_dot2_f32_bf16 v147, v77, v6, v147
    v_dot2_f32_bf16 v148, v78, v5, v148
    v_dot2_f32_bf16 v149, v78, v6, v149
    v_dot2_f32_bf16 v150, v79, v5, v150
    v_dot2_f32_bf16 v151, v79, v6, v151
    s_lshl_b32 s60, s86, 11
    s_add_u32 s60, s60, 0
    v_lshlrev_b32 v7, 5, v0
    v_add_u32 v7, s60, v7
    s_nop 2
    ds_write_b128 v7, v[144:147]
    ds_write_b128 v7, v[148:151] offset:16
    s_waitcnt lgkmcnt(0)
parallel_hq1:
    s_barrier
    s_cmp_ge_u32 s86, 2
    s_cbranch_scc1 parallel_csA
    s_lshl_b32 s60, s86, 6
    v_add_u32 v8, s60, v0
    v_lshrrev_b32 v9, 3, v8
    v_lshlrev_b32 v9, 5, v9
    v_and_b32 v10, 7, v8
    v_lshl_add_u32 v9, v10, 2, v9
    ds_read_b32 v104, v9 offset:0
    ds_read_b32 v105, v9 offset:512
    ds_read_b32 v106, v9 offset:1024
    ds_read_b32 v107, v9 offset:1536
    ds_read_b32 v108, v9 offset:2048
    ds_read_b32 v109, v9 offset:2560
    ds_read_b32 v110, v9 offset:3072
    ds_read_b32 v111, v9 offset:3584
    ds_read_b32 v112, v9 offset:4096
    ds_read_b32 v113, v9 offset:4608
    ds_read_b32 v114, v9 offset:5120
    ds_read_b32 v115, v9 offset:5632
    ds_read_b32 v116, v9 offset:6144
    ds_read_b32 v117, v9 offset:6656
    ds_read_b32 v118, v9 offset:7168
    ds_read_b32 v119, v9 offset:7680
    ds_read_b32 v120, v9 offset:8192
    ds_read_b32 v121, v9 offset:8704
    ds_read_b32 v122, v9 offset:9216
    ds_read_b32 v123, v9 offset:9728
    ds_read_b32 v124, v9 offset:10240
    ds_read_b32 v125, v9 offset:10752
    ds_read_b32 v126, v9 offset:11264
    ds_read_b32 v127, v9 offset:11776
    ds_read_b32 v128, v9 offset:12288
    ds_read_b32 v129, v9 offset:12800
    ds_read_b32 v130, v9 offset:13312
    ds_read_b32 v131, v9 offset:13824
    ds_read_b32 v132, v9 offset:14336
    ds_read_b32 v133, v9 offset:14848
    ds_read_b32 v134, v9 offset:15360
    ds_read_b32 v135, v9 offset:15872
    s_waitcnt lgkmcnt(0)
    v_add_f32 v104, v104, v120
    v_add_f32 v105, v105, v121
    v_add_f32 v106, v106, v122
    v_add_f32 v107, v107, v123
    v_add_f32 v108, v108, v124
    v_add_f32 v109, v109, v125
    v_add_f32 v110, v110, v126
    v_add_f32 v111, v111, v127
    v_add_f32 v112, v112, v128
    v_add_f32 v113, v113, v129
    v_add_f32 v114, v114, v130
    v_add_f32 v115, v115, v131
    v_add_f32 v116, v116, v132
    v_add_f32 v117, v117, v133
    v_add_f32 v118, v118, v134
    v_add_f32 v119, v119, v135
    v_add_f32 v104, v104, v112
    v_add_f32 v105, v105, v113
    v_add_f32 v106, v106, v114
    v_add_f32 v107, v107, v115
    v_add_f32 v108, v108, v116
    v_add_f32 v109, v109, v117
    v_add_f32 v110, v110, v118
    v_add_f32 v111, v111, v119
    v_add_f32 v104, v104, v108
    v_add_f32 v105, v105, v109
    v_add_f32 v106, v106, v110
    v_add_f32 v107, v107, v111
    v_add_f32 v104, v104, v106
    v_add_f32 v105, v105, v107
    v_add_f32 v104, v104, v105
    v_lshlrev_b32 v8, 2, v8
    s_lshl_b32 s60, s43, 9
    s_add_u32 s60, s60, 18915328
    buffer_store_dword v104, v8, s[24:27], s60 offen sc1
parallel_csA:
    s_cmp_ge_u32 s96, 10
    s_cbranch_scc1 parallel_hqs
    s_cmp_ge_u32 s86, 8
    s_cbranch_scc1 parallel_hq2
    s_cmp_lt_u32 s44, 12
    s_mov_b32 s58, 3584
    s_cselect_b32 s57, 3072, s58
    s_cselect_b32 s20, s66, s72
    s_cselect_b32 s21, s67, s73
    s_cselect_b32 s58, 0, 12
    s_lshl_b32 s22, s57, 9
    s_mov_b32 s23, 0x20000
    s_sub_u32 s58, s44, s58
    s_lshl_b32 s58, s58, 8
    v_lshrrev_b32 v3, 4, v0
    v_mul_lo_u32 v3, s57, v3
    v_and_b32 v4, 15, v0
    v_lshl_add_u32 v3, v4, 4, v3
    s_mul_i32 s59, s57, s86
    s_lshl_b32 s59, s59, 2
    s_add_u32 s58, s58, s59
    s_lshl_b32 s59, s57, 5
    buffer_load_dwordx4 v[16:19], v3, s[20:23], s58 offen
    s_add_u32 s58, s58, s59
    buffer_load_dwordx4 v[20:23], v3, s[20:23], s58 offen
    s_add_u32 s58, s58, s59
    buffer_load_dwordx4 v[24:27], v3, s[20:23], s58 offen
    s_add_u32 s58, s58, s59
    buffer_load_dwordx4 v[28:31], v3, s[20:23], s58 offen
    s_add_u32 s58, s58, s59
    buffer_load_dwordx4 v[32:35], v3, s[20:23], s58 offen
    s_add_u32 s58, s58, s59
    buffer_load_dwordx4 v[36:39], v3, s[20:23], s58 offen
    s_add_u32 s58, s58, s59
    buffer_load_dwordx4 v[40:43], v3, s[20:23], s58 offen
    s_add_u32 s58, s58, s59
    buffer_load_dwordx4 v[44:47], v3, s[20:23], s58 offen
    s_add_u32 s58, s58, s59
    buffer_load_dwordx4 v[48:51], v3, s[20:23], s58 offen
    s_add_u32 s58, s58, s59
    buffer_load_dwordx4 v[52:55], v3, s[20:23], s58 offen
    s_add_u32 s58, s58, s59
    buffer_load_dwordx4 v[56:59], v3, s[20:23], s58 offen
    s_add_u32 s58, s58, s59
    buffer_load_dwordx4 v[60:63], v3, s[20:23], s58 offen
    s_add_u32 s58, s58, s59
    buffer_load_dwordx4 v[64:67], v3, s[20:23], s58 offen
    s_add_u32 s58, s58, s59
    buffer_load_dwordx4 v[68:71], v3, s[20:23], s58 offen
    s_add_u32 s58, s58, s59
    buffer_load_dwordx4 v[72:75], v3, s[20:23], s58 offen
    s_add_u32 s58, s58, s59
    buffer_load_dwordx4 v[76:79], v3, s[20:23], s58 offen
    s_add_u32 s58, s58, s59
    s_waitcnt vmcnt(16)
parallel_hq2:
    s_barrier
    s_cmp_lg_u32 s86, 0
    s_cbranch_scc1 parallel_hq3
    s_add_u32 s58, s43, 16
    s_lshl_b32 s58, s58, 2
    v_mov_b32 v3, 0
    v_mov_b32 v2, 1
    s_mov_b64 exec, 0x1
    buffer_atomic_add v2, v3, s[32:35], s58 offen sc1
    s_mov_b64 exec, -1
parallel_hq3:
    s_cmp_ge_u32 s86, 8
    s_cbranch_scc1 parallel_hq4
    v_mov_b32 v144, 0
    v_mov_b32 v145, 0
    v_mov_b32 v146, 0
    v_mov_b32 v147, 0
    v_mov_b32 v148, 0
    v_mov_b32 v149, 0
    v_mov_b32 v150, 0
    v_mov_b32 v151, 0
    s_waitcnt vmcnt(15)
    v_dot2_f32_bf16 v144, v16, v5, v144
    v_dot2_f32_bf16 v145, v16, v6, v145
    v_dot2_f32_bf16 v146, v17, v5, v146
    v_dot2_f32_bf16 v147, v17, v6, v147
    v_dot2_f32_bf16 v148, v18, v5, v148
    v_dot2_f32_bf16 v149, v18, v6, v149
    v_dot2_f32_bf16 v150, v19, v5, v150
    v_dot2_f32_bf16 v151, v19, v6, v151
    s_waitcnt vmcnt(14)
    v_dot2_f32_bf16 v144, v20, v5, v144
    v_dot2_f32_bf16 v145, v20, v6, v145
    v_dot2_f32_bf16 v146, v21, v5, v146
    v_dot2_f32_bf16 v147, v21, v6, v147
    v_dot2_f32_bf16 v148, v22, v5, v148
    v_dot2_f32_bf16 v149, v22, v6, v149
    v_dot2_f32_bf16 v150, v23, v5, v150
    v_dot2_f32_bf16 v151, v23, v6, v151
    s_waitcnt vmcnt(13)
    v_dot2_f32_bf16 v144, v24, v5, v144
    v_dot2_f32_bf16 v145, v24, v6, v145
    v_dot2_f32_bf16 v146, v25, v5, v146
    v_dot2_f32_bf16 v147, v25, v6, v147
    v_dot2_f32_bf16 v148, v26, v5, v148
    v_dot2_f32_bf16 v149, v26, v6, v149
    v_dot2_f32_bf16 v150, v27, v5, v150
    v_dot2_f32_bf16 v151, v27, v6, v151
    s_waitcnt vmcnt(12)
    v_dot2_f32_bf16 v144, v28, v5, v144
    v_dot2_f32_bf16 v145, v28, v6, v145
    v_dot2_f32_bf16 v146, v29, v5, v146
    v_dot2_f32_bf16 v147, v29, v6, v147
    v_dot2_f32_bf16 v148, v30, v5, v148
    v_dot2_f32_bf16 v149, v30, v6, v149
    v_dot2_f32_bf16 v150, v31, v5, v150
    v_dot2_f32_bf16 v151, v31, v6, v151
    s_waitcnt vmcnt(11)
    v_dot2_f32_bf16 v144, v32, v5, v144
    v_dot2_f32_bf16 v145, v32, v6, v145
    v_dot2_f32_bf16 v146, v33, v5, v146
    v_dot2_f32_bf16 v147, v33, v6, v147
    v_dot2_f32_bf16 v148, v34, v5, v148
    v_dot2_f32_bf16 v149, v34, v6, v149
    v_dot2_f32_bf16 v150, v35, v5, v150
    v_dot2_f32_bf16 v151, v35, v6, v151
    s_waitcnt vmcnt(10)
    v_dot2_f32_bf16 v144, v36, v5, v144
    v_dot2_f32_bf16 v145, v36, v6, v145
    v_dot2_f32_bf16 v146, v37, v5, v146
    v_dot2_f32_bf16 v147, v37, v6, v147
    v_dot2_f32_bf16 v148, v38, v5, v148
    v_dot2_f32_bf16 v149, v38, v6, v149
    v_dot2_f32_bf16 v150, v39, v5, v150
    v_dot2_f32_bf16 v151, v39, v6, v151
    s_waitcnt vmcnt(9)
    v_dot2_f32_bf16 v144, v40, v5, v144
    v_dot2_f32_bf16 v145, v40, v6, v145
    v_dot2_f32_bf16 v146, v41, v5, v146
    v_dot2_f32_bf16 v147, v41, v6, v147
    v_dot2_f32_bf16 v148, v42, v5, v148
    v_dot2_f32_bf16 v149, v42, v6, v149
    v_dot2_f32_bf16 v150, v43, v5, v150
    v_dot2_f32_bf16 v151, v43, v6, v151
    s_waitcnt vmcnt(8)
    v_dot2_f32_bf16 v144, v44, v5, v144
    v_dot2_f32_bf16 v145, v44, v6, v145
    v_dot2_f32_bf16 v146, v45, v5, v146
    v_dot2_f32_bf16 v147, v45, v6, v147
    v_dot2_f32_bf16 v148, v46, v5, v148
    v_dot2_f32_bf16 v149, v46, v6, v149
    v_dot2_f32_bf16 v150, v47, v5, v150
    v_dot2_f32_bf16 v151, v47, v6, v151
    s_waitcnt vmcnt(7)
    v_dot2_f32_bf16 v144, v48, v5, v144
    v_dot2_f32_bf16 v145, v48, v6, v145
    v_dot2_f32_bf16 v146, v49, v5, v146
    v_dot2_f32_bf16 v147, v49, v6, v147
    v_dot2_f32_bf16 v148, v50, v5, v148
    v_dot2_f32_bf16 v149, v50, v6, v149
    v_dot2_f32_bf16 v150, v51, v5, v150
    v_dot2_f32_bf16 v151, v51, v6, v151
    s_waitcnt vmcnt(6)
    v_dot2_f32_bf16 v144, v52, v5, v144
    v_dot2_f32_bf16 v145, v52, v6, v145
    v_dot2_f32_bf16 v146, v53, v5, v146
    v_dot2_f32_bf16 v147, v53, v6, v147
    v_dot2_f32_bf16 v148, v54, v5, v148
    v_dot2_f32_bf16 v149, v54, v6, v149
    v_dot2_f32_bf16 v150, v55, v5, v150
    v_dot2_f32_bf16 v151, v55, v6, v151
    s_waitcnt vmcnt(5)
    v_dot2_f32_bf16 v144, v56, v5, v144
    v_dot2_f32_bf16 v145, v56, v6, v145
    v_dot2_f32_bf16 v146, v57, v5, v146
    v_dot2_f32_bf16 v147, v57, v6, v147
    v_dot2_f32_bf16 v148, v58, v5, v148
    v_dot2_f32_bf16 v149, v58, v6, v149
    v_dot2_f32_bf16 v150, v59, v5, v150
    v_dot2_f32_bf16 v151, v59, v6, v151
    s_waitcnt vmcnt(4)
    v_dot2_f32_bf16 v144, v60, v5, v144
    v_dot2_f32_bf16 v145, v60, v6, v145
    v_dot2_f32_bf16 v146, v61, v5, v146
    v_dot2_f32_bf16 v147, v61, v6, v147
    v_dot2_f32_bf16 v148, v62, v5, v148
    v_dot2_f32_bf16 v149, v62, v6, v149
    v_dot2_f32_bf16 v150, v63, v5, v150
    v_dot2_f32_bf16 v151, v63, v6, v151
    s_waitcnt vmcnt(3)
    v_dot2_f32_bf16 v144, v64, v5, v144
    v_dot2_f32_bf16 v145, v64, v6, v145
    v_dot2_f32_bf16 v146, v65, v5, v146
    v_dot2_f32_bf16 v147, v65, v6, v147
    v_dot2_f32_bf16 v148, v66, v5, v148
    v_dot2_f32_bf16 v149, v66, v6, v149
    v_dot2_f32_bf16 v150, v67, v5, v150
    v_dot2_f32_bf16 v151, v67, v6, v151
    s_waitcnt vmcnt(2)
    v_dot2_f32_bf16 v144, v68, v5, v144
    v_dot2_f32_bf16 v145, v68, v6, v145
    v_dot2_f32_bf16 v146, v69, v5, v146
    v_dot2_f32_bf16 v147, v69, v6, v147
    v_dot2_f32_bf16 v148, v70, v5, v148
    v_dot2_f32_bf16 v149, v70, v6, v149
    v_dot2_f32_bf16 v150, v71, v5, v150
    v_dot2_f32_bf16 v151, v71, v6, v151
    s_waitcnt vmcnt(1)
    v_dot2_f32_bf16 v144, v72, v5, v144
    v_dot2_f32_bf16 v145, v72, v6, v145
    v_dot2_f32_bf16 v146, v73, v5, v146
    v_dot2_f32_bf16 v147, v73, v6, v147
    v_dot2_f32_bf16 v148, v74, v5, v148
    v_dot2_f32_bf16 v149, v74, v6, v149
    v_dot2_f32_bf16 v150, v75, v5, v150
    v_dot2_f32_bf16 v151, v75, v6, v151
    s_waitcnt vmcnt(0)
    v_dot2_f32_bf16 v144, v76, v5, v144
    v_dot2_f32_bf16 v145, v76, v6, v145
    v_dot2_f32_bf16 v146, v77, v5, v146
    v_dot2_f32_bf16 v147, v77, v6, v147
    v_dot2_f32_bf16 v148, v78, v5, v148
    v_dot2_f32_bf16 v149, v78, v6, v149
    v_dot2_f32_bf16 v150, v79, v5, v150
    v_dot2_f32_bf16 v151, v79, v6, v151
    s_lshl_b32 s60, s86, 11
    s_add_u32 s60, s60, 16384
    v_lshlrev_b32 v7, 5, v0
    v_add_u32 v7, s60, v7
    s_nop 2
    ds_write_b128 v7, v[144:147]
    ds_write_b128 v7, v[148:151] offset:16
    s_waitcnt lgkmcnt(0)
parallel_hq4:
    s_barrier
    s_cmp_ge_u32 s86, 2
    s_cbranch_scc1 parallel_csB
    s_lshl_b32 s60, s86, 6
    v_add_u32 v8, s60, v0
    v_lshrrev_b32 v9, 3, v8
    v_lshlrev_b32 v9, 5, v9
    v_and_b32 v10, 7, v8
    v_lshl_add_u32 v9, v10, 2, v9
    v_add_u32 v9, 16384, v9
    ds_read_b32 v104, v9 offset:0
    ds_read_b32 v105, v9 offset:512
    ds_read_b32 v106, v9 offset:1024
    ds_read_b32 v107, v9 offset:1536
    ds_read_b32 v108, v9 offset:2048
    ds_read_b32 v109, v9 offset:2560
    ds_read_b32 v110, v9 offset:3072
    ds_read_b32 v111, v9 offset:3584
    ds_read_b32 v112, v9 offset:4096
    ds_read_b32 v113, v9 offset:4608
    ds_read_b32 v114, v9 offset:5120
    ds_read_b32 v115, v9 offset:5632
    ds_read_b32 v116, v9 offset:6144
    ds_read_b32 v117, v9 offset:6656
    ds_read_b32 v118, v9 offset:7168
    ds_read_b32 v119, v9 offset:7680
    ds_read_b32 v120, v9 offset:8192
    ds_read_b32 v121, v9 offset:8704
    ds_read_b32 v122, v9 offset:9216
    ds_read_b32 v123, v9 offset:9728
    ds_read_b32 v124, v9 offset:10240
    ds_read_b32 v125, v9 offset:10752
    ds_read_b32 v126, v9 offset:11264
    ds_read_b32 v127, v9 offset:11776
    ds_read_b32 v128, v9 offset:12288
    ds_read_b32 v129, v9 offset:12800
    ds_read_b32 v130, v9 offset:13312
    ds_read_b32 v131, v9 offset:13824
    ds_read_b32 v132, v9 offset:14336
    ds_read_b32 v133, v9 offset:14848
    ds_read_b32 v134, v9 offset:15360
    ds_read_b32 v135, v9 offset:15872
    s_waitcnt lgkmcnt(0)
    v_add_f32 v104, v104, v120
    v_add_f32 v105, v105, v121
    v_add_f32 v106, v106, v122
    v_add_f32 v107, v107, v123
    v_add_f32 v108, v108, v124
    v_add_f32 v109, v109, v125
    v_add_f32 v110, v110, v126
    v_add_f32 v111, v111, v127
    v_add_f32 v112, v112, v128
    v_add_f32 v113, v113, v129
    v_add_f32 v114, v114, v130
    v_add_f32 v115, v115, v131
    v_add_f32 v116, v116, v132
    v_add_f32 v117, v117, v133
    v_add_f32 v118, v118, v134
    v_add_f32 v119, v119, v135
    v_add_f32 v104, v104, v112
    v_add_f32 v105, v105, v113
    v_add_f32 v106, v106, v114
    v_add_f32 v107, v107, v115
    v_add_f32 v108, v108, v116
    v_add_f32 v109, v109, v117
    v_add_f32 v110, v110, v118
    v_add_f32 v111, v111, v119
    v_add_f32 v104, v104, v108
    v_add_f32 v105, v105, v109
    v_add_f32 v106, v106, v110
    v_add_f32 v107, v107, v111
    v_add_f32 v104, v104, v106
    v_add_f32 v105, v105, v107
    v_add_f32 v104, v104, v105
    v_lshlrev_b32 v8, 2, v8
    s_lshl_b32 s60, s44, 9
    s_add_u32 s60, s60, 18915328
    buffer_store_dword v104, v8, s[24:27], s60 offen sc1
parallel_csB:
    s_mov_b32 s43, s44
parallel_hqs:
    s_waitcnt vmcnt(0)
    s_barrier
    s_cmp_lg_u32 s86, 0
    s_cbranch_scc1 parallel_hwait
    s_add_u32 s58, s43, 16
    s_lshl_b32 s58, s58, 2
    v_mov_b32 v3, 0
    v_mov_b32 v2, 1
    s_mov_b64 exec, 0x1
    buffer_atomic_add v2, v3, s[32:35], s58 offen sc1
    s_mov_b64 exec, -1
parallel_hwait:
    v_mov_b32 v2, 0
    v_lshlrev_b32 v3, 2, v0
    v_add_u32 v3, 155648, v3
    ds_write_b32 v3, v2
    s_waitcnt lgkmcnt(0)
    s_barrier
    s_cmp_lt_u32 s86, 8
    s_cbranch_scc1 parallel_p2attn
    s_cmp_lg_u32 s86, 8
    s_cbranch_scc1 parallel_p2gemm_poll
    s_mov_b32 s32, s82
    s_mov_b32 s33, s83
    s_mov_b32 s34, 256
    s_mov_b32 s35, 0x20000
    v_mov_b32 v3, 0
parallel_hw1:
    buffer_load_dword v2, v3, s[32:35], 0 offen sc1
    s_waitcnt vmcnt(0)
    v_readfirstlane_b32 s58, v2
    s_nop 3
    s_cmp_ge_u32 s58, 8
    s_cbranch_scc1 parallel_p2gemm_poll
    s_sleep 16
    s_branch parallel_hw1
parallel_p2attn:
    s_and_b32 s21, s87, 7
    s_lshl_b32 s21, s21, 2
    s_bfe_u32 s3, s87, 0x20003
    s_add_u32 s21, s21, s3
    s_lshr_b32 s22, s87, 5
    s_lshl_b32 s6, s21, 16
    s_add_u32 s8, s84, s6
    s_addc_u32 s9, s85, 0
    v_lshlrev_b32 v1, 4, v0
    s_lshr_b32 s16, s86, 2
    s_and_b32 s17, s86, 3
    s_lshl_b32 s10, s16, 5
    s_add_u32 s10, s10, s17
    s_lshl_b32 s10, s10, 10
    s_lshl_b32 s23, s22, 3
    s_lshl_b32 s18, s17, 1
    s_add_u32 s23, s23, s18
    s_lshl_b32 s14, s23, 10
    s_add_u32 s28, s8, 2097152
    s_addc_u32 s29, s9, 0
    s_mov_b32 s30, 65536
    s_mov_b32 s31, 0x20000
    s_add_u32 s32, s8, 4194304
    s_addc_u32 s33, s9, 0
    s_mov_b32 s34, 65536
    s_mov_b32 s35, 0x20000
    s_mov_b32 s24, s8
    s_mov_b32 s25, s9
    s_mov_b32 s26, 65536
    s_mov_b32 s27, 0x20000
    s_add_u32 s36, s84, 8388608
    s_addc_u32 s37, s85, 0
    s_mov_b32 s38, 9437184
    s_mov_b32 s39, 0x20000
    v_lshrrev_b32 v3, 5, v0
    v_lshlrev_b32 v3, 8, v3
    v_and_b32 v4, 15, v0
    v_lshlrev_b32 v4, 4, v4
    v_add_u32 v2, v3, v4
    s_lshl_b32 s15, s16, 15
    s_add_u32 s11, s15, 65536
    v_add_u32 v2, s11, v2
    s_mov_b32 s40, 0x0000ffff
    s_mov_b32 s41, 0x0000ffff
    v_and_b32 v3, 27, v0
    v_cmp_eq_u32 vcc, 16, v3
    v_mov_b32 v4, 0x3f803f80
    s_nop 0
    v_cndmask_b32 v3, 0, v4, vcc
    v_mov_b32 v24, v3
    v_mov_b32 v25, v3
    v_mov_b32 v26, v3
    v_mov_b32 v27, v3
    v_mov_b32 v28, v3
    v_mov_b32 v29, v3
    v_mov_b32 v30, v3
    v_mov_b32 v31, v3
    v_mov_b32 v32, v3
    v_mov_b32 v33, v3
    v_mov_b32 v34, v3
    v_mov_b32 v35, v3
    v_mov_b32 v36, v3
    v_mov_b32 v37, v3
    v_mov_b32 v38, v3
    v_mov_b32 v39, v3
    s_mov_b32 s24, s8
    s_mov_b32 s25, s9
    s_mov_b32 s26, 65536
    s_mov_b32 s27, 0x20000
    s_barrier
    s_mov_b32 m0, s10
    s_add_u32 s12, s10, 65536
    buffer_load_dwordx4 v1, s[28:31], s10 offen lds
    buffer_load_dwordx4 v[8:11], v1, s[24:27], s14 offen
    buffer_load_dwordx4 v[12:15], v1, s[24:27], s14 offen offset:1024
    s_mov_b32 m0, s12
    s_nop 0
    buffer_load_dwordx4 v1, s[32:35], s10 offen lds
    s_waitcnt vmcnt(0)
    s_barrier
    s_cmp_eq_u32 s97, 255
    s_cbranch_scc1 parallel_hs_5
    s_waitcnt vmcnt(0) lgkmcnt(0)
    v_mov_b32 v3, 155688
    v_mov_b32 v4, 1
    s_mov_b64 exec, 1
    ds_add_rtn_u32 v6, v3, v4
    s_mov_b64 exec, -1
    s_waitcnt lgkmcnt(0)
    v_readfirstlane_b32 s11, v6
    s_nop 3
    s_cmp_lg_u32 s11, s97
    s_cbranch_scc1 parallel_hs_5
    s_add_u32 s48, s84, 18931712
    s_addc_u32 s49, s85, 0
    s_mov_b32 s50, 24576
    s_mov_b32 s51, 0x20000
    s_mul_i32 s11, s44, 256
    s_add_u32 s11, s11, 8192
    v_lshlrev_b32 v3, 7, v0
    v_mov_b32 v4, 1
    s_mov_b64 exec, 0x3
    buffer_atomic_add v4, v3, s[48:51], s11 offen sc1
    s_mov_b64 exec, -1
parallel_hs_5:
    ds_read_b128 v[16:19], v1 offset:0
    ds_read_b128 v[20:23], v1 offset:1024
    v_add_u32 v1, s15, v1
    s_waitcnt lgkmcnt(1)
    v_mfma_f32_32x32x16_bf16 v[48:63], v[16:19], v[8:11], 0
    v_mfma_f32_32x32x16_bf16 v[80:95], v[16:19], v[12:15], 0
    s_waitcnt lgkmcnt(0)
    v_mfma_f32_32x32x16_bf16 v[64:79], v[20:23], v[8:11], 0
    v_mfma_f32_32x32x16_bf16 v[96:111], v[20:23], v[12:15], 0
    ds_read_b128 v[16:19], v1 offset:0
    s_mov_b64 exec, s[40:41]
    ds_read_b128 v[24:27], v2 offset:0
    ds_read_b128 v[28:31], v2 offset:512
    s_mov_b64 exec, -1
    s_nop 7
    s_nop 3
    v_max3_f32 v3, v48, v49, v50
    v_max3_f32 v3, v3, v51, v52
    v_max3_f32 v3, v3, v53, v54
    v_max3_f32 v3, v3, v55, v56
    v_max3_f32 v3, v3, v57, v58
    v_max3_f32 v3, v3, v59, v60
    v_max3_f32 v3, v3, v61, v62
    v_max3_f32 v3, v3, v63, v64
    v_max3_f32 v3, v3, v65, v66
    v_max3_f32 v3, v3, v67, v68
    v_max3_f32 v3, v3, v69, v70
    v_max3_f32 v3, v3, v71, v72
    v_max3_f32 v3, v3, v73, v74
    v_max3_f32 v3, v3, v75, v76
    v_max3_f32 v3, v3, v77, v78
    v_max_f32 v3, v3, v79
    v_max3_f32 v4, v80, v81, v82
    v_max3_f32 v4, v4, v83, v84
    v_max3_f32 v4, v4, v85, v86
    v_max3_f32 v4, v4, v87, v88
    v_max3_f32 v4, v4, v89, v90
    v_max3_f32 v4, v4, v91, v92
    v_max3_f32 v4, v4, v93, v94
    v_max3_f32 v4, v4, v95, v96
    v_max3_f32 v4, v4, v97, v98
    v_max3_f32 v4, v4, v99, v100
    v_max3_f32 v4, v4, v101, v102
    v_max3_f32 v4, v4, v103, v104
    v_max3_f32 v4, v4, v105, v106
    v_max3_f32 v4, v4, v107, v108
    v_max3_f32 v4, v4, v109, v110
    v_max_f32 v4, v4, v111
    v_mov_b32 v5, v3
    s_nop 1
    v_permlane32_swap_b32 v3, v5
    s_nop 1
    v_max_f32 v3, v3, v5
    v_mov_b32 v5, v4
    s_nop 1
    v_permlane32_swap_b32 v4, v5
    s_nop 1
    v_max_f32 v4, v4, v5
    s_mov_b32 s11, 0xc2b40000
    v_sub_f32 v3, s11, v3
    v_sub_f32 v4, s11, v4
    v_mov_b32 v112, v3
    v_mov_b32 v113, v3
    v_mov_b32 v114, v3
    v_mov_b32 v115, v3
    v_mov_b32 v116, v3
    v_mov_b32 v117, v3
    v_mov_b32 v118, v3
    v_mov_b32 v119, v3
    v_mov_b32 v120, v3
    v_mov_b32 v121, v3
    v_mov_b32 v122, v3
    v_mov_b32 v123, v3
    v_mov_b32 v124, v3
    v_mov_b32 v125, v3
    v_mov_b32 v126, v3
    v_mov_b32 v127, v3
    s_waitcnt lgkmcnt(0)
    s_nop 0
    v_mfma_f32_32x32x16_bf16 v[48:63], v[16:19], v[8:11], v[112:127]
    v_mov_b32 v128, v4
    v_mov_b32 v129, v4
    v_mov_b32 v130, v4
    v_mov_b32 v131, v4
    v_mov_b32 v132, v4
    v_mov_b32 v133, v4
    v_mov_b32 v134, v4
    v_mov_b32 v135, v4
    v_mov_b32 v136, v4
    v_mov_b32 v137, v4
    v_mov_b32 v138, v4
    v_mov_b32 v139, v4
    v_mov_b32 v140, v4
    v_mov_b32 v141, v4
    v_mov_b32 v142, v4
    v_mov_b32 v143, v4
    v_exp_f32 v48, v48
    v_exp_f32 v49, v49
    v_mfma_f32_32x32x16_bf16 v[64:79], v[16:19], v[12:15], v[128:143]
    v_exp_f32 v50, v50
    v_cvt_pk_bf16_f32 v40, v48, v49
    ds_read_b128 v[20:23], v1 offset:1024
    v_exp_f32 v51, v51
    v_exp_f32 v52, v52
    v_cvt_pk_bf16_f32 v41, v50, v51
    v_exp_f32 v53, v53
    v_exp_f32 v54, v54
    v_cvt_pk_bf16_f32 v42, v52, v53
    v_exp_f32 v55, v55
    v_exp_f32 v56, v56
    v_cvt_pk_bf16_f32 v43, v54, v55
    v_exp_f32 v57, v57
    s_waitcnt lgkmcnt(1)
    v_exp_f32 v58, v58
    v_mfma_f32_32x32x16_bf16 v[80:95], v[24:27], v[40:43], 0
    v_cvt_pk_bf16_f32 v44, v56, v57
    v_exp_f32 v59, v59
    v_exp_f32 v60, v60
    v_cvt_pk_bf16_f32 v45, v58, v59
    v_exp_f32 v61, v61
    v_exp_f32 v62, v62
    v_cvt_pk_bf16_f32 v46, v60, v61
    v_exp_f32 v63, v63
    v_exp_f32 v64, v64
    v_cvt_pk_bf16_f32 v47, v62, v63
    v_exp_f32 v65, v65
    s_waitcnt lgkmcnt(0)
    v_mfma_f32_32x32x16_bf16 v[48:63], v[20:23], v[8:11], v[112:127]
    v_exp_f32 v66, v66
    v_cvt_pk_bf16_f32 v40, v64, v65
    v_exp_f32 v67, v67
    v_exp_f32 v68, v68
    v_cvt_pk_bf16_f32 v41, v66, v67
    v_mfma_f32_32x32x16_bf16 v[80:95], v[28:31], v[44:47], v[80:95]
    v_exp_f32 v69, v69
    v_exp_f32 v70, v70
    v_cvt_pk_bf16_f32 v42, v68, v69
    s_mov_b64 exec, s[40:41]
    ds_read_b128 v[32:35], v2 offset:1024
    ds_read_b128 v[36:39], v2 offset:1536
    s_mov_b64 exec, -1
    v_exp_f32 v71, v71
    v_exp_f32 v72, v72
    v_cvt_pk_bf16_f32 v43, v70, v71
    v_exp_f32 v73, v73
    v_exp_f32 v74, v74
    v_mfma_f32_32x32x16_bf16 v[96:111], v[24:27], v[40:43], 0
    v_cvt_pk_bf16_f32 v44, v72, v73
    v_exp_f32 v75, v75
    v_exp_f32 v76, v76
    v_cvt_pk_bf16_f32 v45, v74, v75
    v_exp_f32 v77, v77
    v_exp_f32 v78, v78
    v_cvt_pk_bf16_f32 v46, v76, v77
    v_exp_f32 v79, v79
    v_exp_f32 v48, v48
    v_cvt_pk_bf16_f32 v47, v78, v79
    v_exp_f32 v49, v49
    v_mfma_f32_32x32x16_bf16 v[64:79], v[20:23], v[12:15], v[128:143]
    v_exp_f32 v50, v50
    v_cvt_pk_bf16_f32 v40, v48, v49
    ds_read_b128 v[16:19], v1 offset:2048
    v_exp_f32 v51, v51
    v_exp_f32 v52, v52
    v_cvt_pk_bf16_f32 v41, v50, v51
    v_mfma_f32_32x32x16_bf16 v[96:111], v[28:31], v[44:47], v[96:111]
    v_exp_f32 v53, v53
    v_exp_f32 v54, v54
    v_cvt_pk_bf16_f32 v42, v52, v53
    v_exp_f32 v55, v55
    v_exp_f32 v56, v56
    v_cvt_pk_bf16_f32 v43, v54, v55
    v_exp_f32 v57, v57
    s_waitcnt lgkmcnt(1)
    v_exp_f32 v58, v58
    v_mfma_f32_32x32x16_bf16 v[80:95], v[32:35], v[40:43], v[80:95]
    v_cvt_pk_bf16_f32 v44, v56, v57
    v_exp_f32 v59, v59
    v_exp_f32 v60, v60
    v_cvt_pk_bf16_f32 v45, v58, v59
    v_exp_f32 v61, v61
    v_exp_f32 v62, v62
    v_cvt_pk_bf16_f32 v46, v60, v61
    v_exp_f32 v63, v63
    v_exp_f32 v64, v64
    v_cvt_pk_bf16_f32 v47, v62, v63
    v_exp_f32 v65, v65
    s_waitcnt lgkmcnt(0)
    v_mfma_f32_32x32x16_bf16 v[48:63], v[16:19], v[8:11], v[112:127]
    v_exp_f32 v66, v66
    v_cvt_pk_bf16_f32 v40, v64, v65
    v_exp_f32 v67, v67
    v_exp_f32 v68, v68
    v_cvt_pk_bf16_f32 v41, v66, v67
    v_mfma_f32_32x32x16_bf16 v[80:95], v[36:39], v[44:47], v[80:95]
    v_exp_f32 v69, v69
    v_exp_f32 v70, v70
    v_cvt_pk_bf16_f32 v42, v68, v69
    s_mov_b64 exec, s[40:41]
    ds_read_b128 v[24:27], v2 offset:2048
    ds_read_b128 v[28:31], v2 offset:2560
    s_mov_b64 exec, -1
    v_exp_f32 v71, v71
    v_exp_f32 v72, v72
    v_cvt_pk_bf16_f32 v43, v70, v71
    v_exp_f32 v73, v73
    v_exp_f32 v74, v74
    v_mfma_f32_32x32x16_bf16 v[96:111], v[32:35], v[40:43], v[96:111]
    v_cvt_pk_bf16_f32 v44, v72, v73
    v_exp_f32 v75, v75
    v_exp_f32 v76, v76
    v_cvt_pk_bf16_f32 v45, v74, v75
    v_exp_f32 v77, v77
    v_exp_f32 v78, v78
    v_cvt_pk_bf16_f32 v46, v76, v77
    v_exp_f32 v79, v79
    v_exp_f32 v48, v48
    v_cvt_pk_bf16_f32 v47, v78, v79
    v_exp_f32 v49, v49
    v_mfma_f32_32x32x16_bf16 v[64:79], v[16:19], v[12:15], v[128:143]
    v_exp_f32 v50, v50
    v_cvt_pk_bf16_f32 v40, v48, v49
    ds_read_b128 v[20:23], v1 offset:3072
    v_exp_f32 v51, v51
    v_exp_f32 v52, v52
    v_cvt_pk_bf16_f32 v41, v50, v51
    v_mfma_f32_32x32x16_bf16 v[96:111], v[36:39], v[44:47], v[96:111]
    v_exp_f32 v53, v53
    v_exp_f32 v54, v54
    v_cvt_pk_bf16_f32 v42, v52, v53
    v_exp_f32 v55, v55
    v_exp_f32 v56, v56
    v_cvt_pk_bf16_f32 v43, v54, v55
    v_exp_f32 v57, v57
    s_waitcnt lgkmcnt(1)
    v_exp_f32 v58, v58
    v_mfma_f32_32x32x16_bf16 v[80:95], v[24:27], v[40:43], v[80:95]
    v_cvt_pk_bf16_f32 v44, v56, v57
    v_exp_f32 v59, v59
    v_exp_f32 v60, v60
    v_cvt_pk_bf16_f32 v45, v58, v59
    v_exp_f32 v61, v61
    v_exp_f32 v62, v62
    v_cvt_pk_bf16_f32 v46, v60, v61
    v_exp_f32 v63, v63
    v_exp_f32 v64, v64
    v_cvt_pk_bf16_f32 v47, v62, v63
    v_exp_f32 v65, v65
    s_waitcnt lgkmcnt(0)
    v_mfma_f32_32x32x16_bf16 v[48:63], v[20:23], v[8:11], v[112:127]
    v_exp_f32 v66, v66
    v_cvt_pk_bf16_f32 v40, v64, v65
    v_exp_f32 v67, v67
    v_exp_f32 v68, v68
    v_cvt_pk_bf16_f32 v41, v66, v67
    v_mfma_f32_32x32x16_bf16 v[80:95], v[28:31], v[44:47], v[80:95]
    v_exp_f32 v69, v69
    v_exp_f32 v70, v70
    v_cvt_pk_bf16_f32 v42, v68, v69
    s_mov_b64 exec, s[40:41]
    ds_read_b128 v[32:35], v2 offset:3072
    ds_read_b128 v[36:39], v2 offset:3584
    s_mov_b64 exec, -1
    v_exp_f32 v71, v71
    v_exp_f32 v72, v72
    v_cvt_pk_bf16_f32 v43, v70, v71
    v_exp_f32 v73, v73
    v_exp_f32 v74, v74
    v_mfma_f32_32x32x16_bf16 v[96:111], v[24:27], v[40:43], v[96:111]
    v_cvt_pk_bf16_f32 v44, v72, v73
    v_exp_f32 v75, v75
    v_exp_f32 v76, v76
    v_cvt_pk_bf16_f32 v45, v74, v75
    v_exp_f32 v77, v77
    v_exp_f32 v78, v78
    v_cvt_pk_bf16_f32 v46, v76, v77
    v_exp_f32 v79, v79
    s_barrier
    v_exp_f32 v48, v48
    v_cvt_pk_bf16_f32 v47, v78, v79
    v_exp_f32 v49, v49
    v_mfma_f32_32x32x16_bf16 v[64:79], v[20:23], v[12:15], v[128:143]
    v_exp_f32 v50, v50
    v_cvt_pk_bf16_f32 v40, v48, v49
    ds_read_b128 v[16:19], v1 offset:4096
    v_exp_f32 v51, v51
    v_exp_f32 v52, v52
    v_cvt_pk_bf16_f32 v41, v50, v51
    v_mfma_f32_32x32x16_bf16 v[96:111], v[28:31], v[44:47], v[96:111]
    v_exp_f32 v53, v53
    v_exp_f32 v54, v54
    v_cvt_pk_bf16_f32 v42, v52, v53
    v_exp_f32 v55, v55
    v_exp_f32 v56, v56
    v_cvt_pk_bf16_f32 v43, v54, v55
    v_exp_f32 v57, v57
    s_waitcnt lgkmcnt(1)
    v_exp_f32 v58, v58
    v_mfma_f32_32x32x16_bf16 v[80:95], v[32:35], v[40:43], v[80:95]
    v_cvt_pk_bf16_f32 v44, v56, v57
    v_exp_f32 v59, v59
    v_exp_f32 v60, v60
    v_cvt_pk_bf16_f32 v45, v58, v59
    v_exp_f32 v61, v61
    v_exp_f32 v62, v62
    v_cvt_pk_bf16_f32 v46, v60, v61
    v_exp_f32 v63, v63
    v_exp_f32 v64, v64
    v_cvt_pk_bf16_f32 v47, v62, v63
    v_exp_f32 v65, v65
    s_waitcnt lgkmcnt(0)
    v_mfma_f32_32x32x16_bf16 v[48:63], v[16:19], v[8:11], v[112:127]
    v_exp_f32 v66, v66
    v_cvt_pk_bf16_f32 v40, v64, v65
    v_exp_f32 v67, v67
    v_exp_f32 v68, v68
    v_cvt_pk_bf16_f32 v41, v66, v67
    v_mfma_f32_32x32x16_bf16 v[80:95], v[36:39], v[44:47], v[80:95]
    v_exp_f32 v69, v69
    v_exp_f32 v70, v70
    v_cvt_pk_bf16_f32 v42, v68, v69
    s_mov_b64 exec, s[40:41]
    ds_read_b128 v[24:27], v2 offset:4096
    ds_read_b128 v[28:31], v2 offset:4608
    s_mov_b64 exec, -1
    v_exp_f32 v71, v71
    v_exp_f32 v72, v72
    v_cvt_pk_bf16_f32 v43, v70, v71
    v_exp_f32 v73, v73
    v_exp_f32 v74, v74
    v_mfma_f32_32x32x16_bf16 v[96:111], v[32:35], v[40:43], v[96:111]
    v_cvt_pk_bf16_f32 v44, v72, v73
    v_exp_f32 v75, v75
    v_exp_f32 v76, v76
    v_cvt_pk_bf16_f32 v45, v74, v75
    v_exp_f32 v77, v77
    v_exp_f32 v78, v78
    v_cvt_pk_bf16_f32 v46, v76, v77
    v_exp_f32 v79, v79
    v_exp_f32 v48, v48
    v_cvt_pk_bf16_f32 v47, v78, v79
    v_exp_f32 v49, v49
    v_mfma_f32_32x32x16_bf16 v[64:79], v[16:19], v[12:15], v[128:143]
    v_exp_f32 v50, v50
    v_cvt_pk_bf16_f32 v40, v48, v49
    ds_read_b128 v[20:23], v1 offset:5120
    v_exp_f32 v51, v51
    v_exp_f32 v52, v52
    v_cvt_pk_bf16_f32 v41, v50, v51
    v_mfma_f32_32x32x16_bf16 v[96:111], v[36:39], v[44:47], v[96:111]
    v_exp_f32 v53, v53
    v_exp_f32 v54, v54
    v_cvt_pk_bf16_f32 v42, v52, v53
    v_exp_f32 v55, v55
    v_exp_f32 v56, v56
    v_cvt_pk_bf16_f32 v43, v54, v55
    v_exp_f32 v57, v57
    s_waitcnt lgkmcnt(1)
    v_exp_f32 v58, v58
    v_mfma_f32_32x32x16_bf16 v[80:95], v[24:27], v[40:43], v[80:95]
    v_cvt_pk_bf16_f32 v44, v56, v57
    v_exp_f32 v59, v59
    v_exp_f32 v60, v60
    v_cvt_pk_bf16_f32 v45, v58, v59
    v_exp_f32 v61, v61
    v_exp_f32 v62, v62
    v_cvt_pk_bf16_f32 v46, v60, v61
    v_exp_f32 v63, v63
    v_exp_f32 v64, v64
    v_cvt_pk_bf16_f32 v47, v62, v63
    v_exp_f32 v65, v65
    s_waitcnt lgkmcnt(0)
    v_mfma_f32_32x32x16_bf16 v[48:63], v[20:23], v[8:11], v[112:127]
    v_exp_f32 v66, v66
    v_cvt_pk_bf16_f32 v40, v64, v65
    v_exp_f32 v67, v67
    v_exp_f32 v68, v68
    v_cvt_pk_bf16_f32 v41, v66, v67
    v_mfma_f32_32x32x16_bf16 v[80:95], v[28:31], v[44:47], v[80:95]
    v_exp_f32 v69, v69
    v_exp_f32 v70, v70
    v_cvt_pk_bf16_f32 v42, v68, v69
    s_mov_b64 exec, s[40:41]
    ds_read_b128 v[32:35], v2 offset:5120
    ds_read_b128 v[36:39], v2 offset:5632
    s_mov_b64 exec, -1
    v_exp_f32 v71, v71
    v_exp_f32 v72, v72
    v_cvt_pk_bf16_f32 v43, v70, v71
    v_exp_f32 v73, v73
    v_exp_f32 v74, v74
    v_mfma_f32_32x32x16_bf16 v[96:111], v[24:27], v[40:43], v[96:111]
    v_cvt_pk_bf16_f32 v44, v72, v73
    v_exp_f32 v75, v75
    v_exp_f32 v76, v76
    v_cvt_pk_bf16_f32 v45, v74, v75
    v_exp_f32 v77, v77
    v_exp_f32 v78, v78
    v_cvt_pk_bf16_f32 v46, v76, v77
    v_exp_f32 v79, v79
    v_exp_f32 v48, v48
    v_cvt_pk_bf16_f32 v47, v78, v79
    v_exp_f32 v49, v49
    v_mfma_f32_32x32x16_bf16 v[64:79], v[20:23], v[12:15], v[128:143]
    v_exp_f32 v50, v50
    v_cvt_pk_bf16_f32 v40, v48, v49
    ds_read_b128 v[16:19], v1 offset:6144
    v_exp_f32 v51, v51
    v_exp_f32 v52, v52
    v_cvt_pk_bf16_f32 v41, v50, v51
    v_mfma_f32_32x32x16_bf16 v[96:111], v[28:31], v[44:47], v[96:111]
    v_exp_f32 v53, v53
    v_exp_f32 v54, v54
    v_cvt_pk_bf16_f32 v42, v52, v53
    v_exp_f32 v55, v55
    v_exp_f32 v56, v56
    v_cvt_pk_bf16_f32 v43, v54, v55
    v_exp_f32 v57, v57
    s_waitcnt lgkmcnt(1)
    v_exp_f32 v58, v58
    v_mfma_f32_32x32x16_bf16 v[80:95], v[32:35], v[40:43], v[80:95]
    v_cvt_pk_bf16_f32 v44, v56, v57
    v_exp_f32 v59, v59
    v_exp_f32 v60, v60
    v_cvt_pk_bf16_f32 v45, v58, v59
    v_exp_f32 v61, v61
    v_exp_f32 v62, v62
    v_cvt_pk_bf16_f32 v46, v60, v61
    v_exp_f32 v63, v63
    v_exp_f32 v64, v64
    v_cvt_pk_bf16_f32 v47, v62, v63
    v_exp_f32 v65, v65
    s_waitcnt lgkmcnt(0)
    v_mfma_f32_32x32x16_bf16 v[48:63], v[16:19], v[8:11], v[112:127]
    v_exp_f32 v66, v66
    v_cvt_pk_bf16_f32 v40, v64, v65
    v_exp_f32 v67, v67
    v_exp_f32 v68, v68
    v_cvt_pk_bf16_f32 v41, v66, v67
    v_mfma_f32_32x32x16_bf16 v[80:95], v[36:39], v[44:47], v[80:95]
    v_exp_f32 v69, v69
    v_exp_f32 v70, v70
    v_cvt_pk_bf16_f32 v42, v68, v69
    s_mov_b64 exec, s[40:41]
    ds_read_b128 v[24:27], v2 offset:6144
    ds_read_b128 v[28:31], v2 offset:6656
    s_mov_b64 exec, -1
    v_exp_f32 v71, v71
    v_exp_f32 v72, v72
    v_cvt_pk_bf16_f32 v43, v70, v71
    v_exp_f32 v73, v73
    v_exp_f32 v74, v74
    v_mfma_f32_32x32x16_bf16 v[96:111], v[32:35], v[40:43], v[96:111]
    v_cvt_pk_bf16_f32 v44, v72, v73
    v_exp_f32 v75, v75
    v_exp_f32 v76, v76
    v_cvt_pk_bf16_f32 v45, v74, v75
    v_exp_f32 v77, v77
    v_exp_f32 v78, v78
    v_cvt_pk_bf16_f32 v46, v76, v77
    v_exp_f32 v79, v79
    v_exp_f32 v48, v48
    v_cvt_pk_bf16_f32 v47, v78, v79
    v_exp_f32 v49, v49
    v_mfma_f32_32x32x16_bf16 v[64:79], v[16:19], v[12:15], v[128:143]
    v_exp_f32 v50, v50
    v_cvt_pk_bf16_f32 v40, v48, v49
    ds_read_b128 v[20:23], v1 offset:7168
    v_exp_f32 v51, v51
    v_exp_f32 v52, v52
    v_cvt_pk_bf16_f32 v41, v50, v51
    v_mfma_f32_32x32x16_bf16 v[96:111], v[36:39], v[44:47], v[96:111]
    v_exp_f32 v53, v53
    v_exp_f32 v54, v54
    v_cvt_pk_bf16_f32 v42, v52, v53
    v_exp_f32 v55, v55
    v_exp_f32 v56, v56
    v_cvt_pk_bf16_f32 v43, v54, v55
    v_exp_f32 v57, v57
    s_waitcnt lgkmcnt(1)
    v_exp_f32 v58, v58
    v_mfma_f32_32x32x16_bf16 v[80:95], v[24:27], v[40:43], v[80:95]
    v_cvt_pk_bf16_f32 v44, v56, v57
    v_exp_f32 v59, v59
    v_exp_f32 v60, v60
    v_cvt_pk_bf16_f32 v45, v58, v59
    v_exp_f32 v61, v61
    v_exp_f32 v62, v62
    v_cvt_pk_bf16_f32 v46, v60, v61
    v_exp_f32 v63, v63
    v_exp_f32 v64, v64
    v_cvt_pk_bf16_f32 v47, v62, v63
    v_exp_f32 v65, v65
    s_waitcnt lgkmcnt(0)
    v_mfma_f32_32x32x16_bf16 v[48:63], v[20:23], v[8:11], v[112:127]
    v_exp_f32 v66, v66
    v_cvt_pk_bf16_f32 v40, v64, v65
    v_exp_f32 v67, v67
    v_exp_f32 v68, v68
    v_cvt_pk_bf16_f32 v41, v66, v67
    v_mfma_f32_32x32x16_bf16 v[80:95], v[28:31], v[44:47], v[80:95]
    v_exp_f32 v69, v69
    v_exp_f32 v70, v70
    v_cvt_pk_bf16_f32 v42, v68, v69
    s_mov_b64 exec, s[40:41]
    ds_read_b128 v[32:35], v2 offset:7168
    ds_read_b128 v[36:39], v2 offset:7680
    s_mov_b64 exec, -1
    v_exp_f32 v71, v71
    v_exp_f32 v72, v72
    v_cvt_pk_bf16_f32 v43, v70, v71
    v_exp_f32 v73, v73
    v_exp_f32 v74, v74
    v_mfma_f32_32x32x16_bf16 v[96:111], v[24:27], v[40:43], v[96:111]
    v_cvt_pk_bf16_f32 v44, v72, v73
    v_exp_f32 v75, v75
    v_exp_f32 v76, v76
    v_cvt_pk_bf16_f32 v45, v74, v75
    v_exp_f32 v77, v77
    v_exp_f32 v78, v78
    v_cvt_pk_bf16_f32 v46, v76, v77
    v_exp_f32 v79, v79
    v_exp_f32 v48, v48
    v_cvt_pk_bf16_f32 v47, v78, v79
    v_exp_f32 v49, v49
    v_mfma_f32_32x32x16_bf16 v[64:79], v[20:23], v[12:15], v[128:143]
    v_exp_f32 v50, v50
    v_cvt_pk_bf16_f32 v40, v48, v49
    ds_read_b128 v[16:19], v1 offset:8192
    v_exp_f32 v51, v51
    v_exp_f32 v52, v52
    v_cvt_pk_bf16_f32 v41, v50, v51
    v_mfma_f32_32x32x16_bf16 v[96:111], v[28:31], v[44:47], v[96:111]
    v_exp_f32 v53, v53
    v_exp_f32 v54, v54
    v_cvt_pk_bf16_f32 v42, v52, v53
    v_exp_f32 v55, v55
    v_exp_f32 v56, v56
    v_cvt_pk_bf16_f32 v43, v54, v55
    v_exp_f32 v57, v57
    s_waitcnt lgkmcnt(1)
    v_exp_f32 v58, v58
    v_mfma_f32_32x32x16_bf16 v[80:95], v[32:35], v[40:43], v[80:95]
    v_cvt_pk_bf16_f32 v44, v56, v57
    v_exp_f32 v59, v59
    v_exp_f32 v60, v60
    v_cvt_pk_bf16_f32 v45, v58, v59
    v_exp_f32 v61, v61
    v_exp_f32 v62, v62
    v_cvt_pk_bf16_f32 v46, v60, v61
    v_exp_f32 v63, v63
    v_exp_f32 v64, v64
    v_cvt_pk_bf16_f32 v47, v62, v63
    v_exp_f32 v65, v65
    s_waitcnt lgkmcnt(0)
    v_mfma_f32_32x32x16_bf16 v[48:63], v[16:19], v[8:11], v[112:127]
    v_exp_f32 v66, v66
    v_cvt_pk_bf16_f32 v40, v64, v65
    v_exp_f32 v67, v67
    v_exp_f32 v68, v68
    v_cvt_pk_bf16_f32 v41, v66, v67
    v_mfma_f32_32x32x16_bf16 v[80:95], v[36:39], v[44:47], v[80:95]
    v_exp_f32 v69, v69
    v_exp_f32 v70, v70
    v_cvt_pk_bf16_f32 v42, v68, v69
    s_mov_b64 exec, s[40:41]
    ds_read_b128 v[24:27], v2 offset:8192
    ds_read_b128 v[28:31], v2 offset:8704
    s_mov_b64 exec, -1
    v_exp_f32 v71, v71
    v_exp_f32 v72, v72
    v_cvt_pk_bf16_f32 v43, v70, v71
    v_exp_f32 v73, v73
    v_exp_f32 v74, v74
    v_mfma_f32_32x32x16_bf16 v[96:111], v[32:35], v[40:43], v[96:111]
    v_cvt_pk_bf16_f32 v44, v72, v73
    v_exp_f32 v75, v75
    v_exp_f32 v76, v76
    v_cvt_pk_bf16_f32 v45, v74, v75
    v_exp_f32 v77, v77
    v_exp_f32 v78, v78
    v_cvt_pk_bf16_f32 v46, v76, v77
    v_exp_f32 v79, v79
    v_add_u32 v1, 0x2000, v1
    v_add_u32 v2, 0x2000, v2
    s_mov_b32 s10, 2
.p2align 6
parallel_loop:
    v_exp_f32 v48, v48
    v_cvt_pk_bf16_f32 v47, v78, v79
    v_exp_f32 v49, v49
    v_mfma_f32_32x32x16_bf16 v[64:79], v[16:19], v[12:15], v[128:143]
    v_exp_f32 v50, v50
    v_cvt_pk_bf16_f32 v40, v48, v49
    ds_read_b128 v[20:23], v1 offset:1024
    v_exp_f32 v51, v51
    v_exp_f32 v52, v52
    v_cvt_pk_bf16_f32 v41, v50, v51
    v_mfma_f32_32x32x16_bf16 v[96:111], v[36:39], v[44:47], v[96:111]
    v_exp_f32 v53, v53
    v_exp_f32 v54, v54
    v_cvt_pk_bf16_f32 v42, v52, v53
    v_exp_f32 v55, v55
    v_exp_f32 v56, v56
    v_cvt_pk_bf16_f32 v43, v54, v55
    v_exp_f32 v57, v57
    s_waitcnt lgkmcnt(1)
    v_exp_f32 v58, v58
    v_mfma_f32_32x32x16_bf16 v[80:95], v[24:27], v[40:43], v[80:95]
    v_cvt_pk_bf16_f32 v44, v56, v57
    v_exp_f32 v59, v59
    v_exp_f32 v60, v60
    v_cvt_pk_bf16_f32 v45, v58, v59
    v_exp_f32 v61, v61
    v_exp_f32 v62, v62
    v_cvt_pk_bf16_f32 v46, v60, v61
    v_exp_f32 v63, v63
    v_exp_f32 v64, v64
    v_cvt_pk_bf16_f32 v47, v62, v63
    v_exp_f32 v65, v65
    s_waitcnt lgkmcnt(0)
    v_mfma_f32_32x32x16_bf16 v[48:63], v[20:23], v[8:11], v[112:127]
    v_exp_f32 v66, v66
    v_cvt_pk_bf16_f32 v40, v64, v65
    v_exp_f32 v67, v67
    v_exp_f32 v68, v68
    v_cvt_pk_bf16_f32 v41, v66, v67
    v_mfma_f32_32x32x16_bf16 v[80:95], v[28:31], v[44:47], v[80:95]
    v_exp_f32 v69, v69
    v_exp_f32 v70, v70
    v_cvt_pk_bf16_f32 v42, v68, v69
    s_mov_b64 exec, s[40:41]
    ds_read_b128 v[32:35], v2 offset:1024
    ds_read_b128 v[36:39], v2 offset:1536
    s_mov_b64 exec, -1
    v_exp_f32 v71, v71
    v_exp_f32 v72, v72
    v_cvt_pk_bf16_f32 v43, v70, v71
    v_exp_f32 v73, v73
    v_exp_f32 v74, v74
    v_mfma_f32_32x32x16_bf16 v[96:111], v[24:27], v[40:43], v[96:111]
    v_cvt_pk_bf16_f32 v44, v72, v73
    v_exp_f32 v75, v75
    v_exp_f32 v76, v76
    v_cvt_pk_bf16_f32 v45, v74, v75
    v_exp_f32 v77, v77
    v_exp_f32 v78, v78
    v_cvt_pk_bf16_f32 v46, v76, v77
    v_exp_f32 v79, v79
    v_exp_f32 v48, v48
    v_cvt_pk_bf16_f32 v47, v78, v79
    v_exp_f32 v49, v49
    v_mfma_f32_32x32x16_bf16 v[64:79], v[20:23], v[12:15], v[128:143]
    v_exp_f32 v50, v50
    v_cvt_pk_bf16_f32 v40, v48, v49
    ds_read_b128 v[16:19], v1 offset:2048
    v_exp_f32 v51, v51
    v_exp_f32 v52, v52
    v_cvt_pk_bf16_f32 v41, v50, v51
    v_mfma_f32_32x32x16_bf16 v[96:111], v[28:31], v[44:47], v[96:111]
    v_exp_f32 v53, v53
    v_exp_f32 v54, v54
    v_cvt_pk_bf16_f32 v42, v52, v53
    v_exp_f32 v55, v55
    v_exp_f32 v56, v56
    v_cvt_pk_bf16_f32 v43, v54, v55
    v_exp_f32 v57, v57
    s_waitcnt lgkmcnt(1)
    v_exp_f32 v58, v58
    v_mfma_f32_32x32x16_bf16 v[80:95], v[32:35], v[40:43], v[80:95]
    v_cvt_pk_bf16_f32 v44, v56, v57
    v_exp_f32 v59, v59
    v_exp_f32 v60, v60
    v_cvt_pk_bf16_f32 v45, v58, v59
    v_exp_f32 v61, v61
    v_exp_f32 v62, v62
    v_cvt_pk_bf16_f32 v46, v60, v61
    v_exp_f32 v63, v63
    v_exp_f32 v64, v64
    v_cvt_pk_bf16_f32 v47, v62, v63
    v_exp_f32 v65, v65
    s_waitcnt lgkmcnt(0)
    v_mfma_f32_32x32x16_bf16 v[48:63], v[16:19], v[8:11], v[112:127]
    v_exp_f32 v66, v66
    v_cvt_pk_bf16_f32 v40, v64, v65
    v_exp_f32 v67, v67
    v_exp_f32 v68, v68
    v_cvt_pk_bf16_f32 v41, v66, v67
    v_mfma_f32_32x32x16_bf16 v[80:95], v[36:39], v[44:47], v[80:95]
    v_exp_f32 v69, v69
    v_exp_f32 v70, v70
    v_cvt_pk_bf16_f32 v42, v68, v69
    s_mov_b64 exec, s[40:41]
    ds_read_b128 v[24:27], v2 offset:2048
    ds_read_b128 v[28:31], v2 offset:2560
    s_mov_b64 exec, -1
    v_exp_f32 v71, v71
    v_exp_f32 v72, v72
    v_cvt_pk_bf16_f32 v43, v70, v71
    v_exp_f32 v73, v73
    v_exp_f32 v74, v74
    v_mfma_f32_32x32x16_bf16 v[96:111], v[32:35], v[40:43], v[96:111]
    v_cvt_pk_bf16_f32 v44, v72, v73
    v_exp_f32 v75, v75
    v_exp_f32 v76, v76
    v_cvt_pk_bf16_f32 v45, v74, v75
    v_exp_f32 v77, v77
    v_exp_f32 v78, v78
    v_cvt_pk_bf16_f32 v46, v76, v77
    v_exp_f32 v79, v79
    v_exp_f32 v48, v48
    v_cvt_pk_bf16_f32 v47, v78, v79
    v_exp_f32 v49, v49
    v_mfma_f32_32x32x16_bf16 v[64:79], v[16:19], v[12:15], v[128:143]
    v_exp_f32 v50, v50
    v_cvt_pk_bf16_f32 v40, v48, v49
    ds_read_b128 v[20:23], v1 offset:3072
    v_exp_f32 v51, v51
    v_exp_f32 v52, v52
    v_cvt_pk_bf16_f32 v41, v50, v51
    v_mfma_f32_32x32x16_bf16 v[96:111], v[36:39], v[44:47], v[96:111]
    v_exp_f32 v53, v53
    v_exp_f32 v54, v54
    v_cvt_pk_bf16_f32 v42, v52, v53
    v_exp_f32 v55, v55
    v_exp_f32 v56, v56
    v_cvt_pk_bf16_f32 v43, v54, v55
    v_exp_f32 v57, v57
    s_waitcnt lgkmcnt(1)
    v_exp_f32 v58, v58
    v_mfma_f32_32x32x16_bf16 v[80:95], v[24:27], v[40:43], v[80:95]
    v_cvt_pk_bf16_f32 v44, v56, v57
    v_exp_f32 v59, v59
    v_exp_f32 v60, v60
    v_cvt_pk_bf16_f32 v45, v58, v59
    v_exp_f32 v61, v61
    v_exp_f32 v62, v62
    v_cvt_pk_bf16_f32 v46, v60, v61
    v_exp_f32 v63, v63
    v_exp_f32 v64, v64
    v_cvt_pk_bf16_f32 v47, v62, v63
    v_exp_f32 v65, v65
    s_waitcnt lgkmcnt(0)
    v_mfma_f32_32x32x16_bf16 v[48:63], v[20:23], v[8:11], v[112:127]
    v_exp_f32 v66, v66
    v_cvt_pk_bf16_f32 v40, v64, v65
    v_exp_f32 v67, v67
    v_exp_f32 v68, v68
    v_cvt_pk_bf16_f32 v41, v66, v67
    v_mfma_f32_32x32x16_bf16 v[80:95], v[28:31], v[44:47], v[80:95]
    v_exp_f32 v69, v69
    v_exp_f32 v70, v70
    v_cvt_pk_bf16_f32 v42, v68, v69
    s_mov_b64 exec, s[40:41]
    ds_read_b128 v[32:35], v2 offset:3072
    ds_read_b128 v[36:39], v2 offset:3584
    s_mov_b64 exec, -1
    v_exp_f32 v71, v71
    v_exp_f32 v72, v72
    v_cvt_pk_bf16_f32 v43, v70, v71
    v_exp_f32 v73, v73
    v_exp_f32 v74, v74
    v_mfma_f32_32x32x16_bf16 v[96:111], v[24:27], v[40:43], v[96:111]
    v_cvt_pk_bf16_f32 v44, v72, v73
    v_exp_f32 v75, v75
    v_exp_f32 v76, v76
    v_cvt_pk_bf16_f32 v45, v74, v75
    v_exp_f32 v77, v77
    v_exp_f32 v78, v78
    v_cvt_pk_bf16_f32 v46, v76, v77
    v_exp_f32 v79, v79
    v_exp_f32 v48, v48
    v_cvt_pk_bf16_f32 v47, v78, v79
    v_exp_f32 v49, v49
    v_mfma_f32_32x32x16_bf16 v[64:79], v[20:23], v[12:15], v[128:143]
    v_exp_f32 v50, v50
    v_cvt_pk_bf16_f32 v40, v48, v49
    ds_read_b128 v[16:19], v1 offset:4096
    v_exp_f32 v51, v51
    v_exp_f32 v52, v52
    v_cvt_pk_bf16_f32 v41, v50, v51
    v_mfma_f32_32x32x16_bf16 v[96:111], v[28:31], v[44:47], v[96:111]
    v_exp_f32 v53, v53
    v_exp_f32 v54, v54
    v_cvt_pk_bf16_f32 v42, v52, v53
    v_exp_f32 v55, v55
    v_exp_f32 v56, v56
    v_cvt_pk_bf16_f32 v43, v54, v55
    v_exp_f32 v57, v57
    s_waitcnt lgkmcnt(1)
    v_exp_f32 v58, v58
    v_mfma_f32_32x32x16_bf16 v[80:95], v[32:35], v[40:43], v[80:95]
    v_cvt_pk_bf16_f32 v44, v56, v57
    v_exp_f32 v59, v59
    v_exp_f32 v60, v60
    v_cvt_pk_bf16_f32 v45, v58, v59
    v_exp_f32 v61, v61
    v_exp_f32 v62, v62
    v_cvt_pk_bf16_f32 v46, v60, v61
    v_exp_f32 v63, v63
    v_exp_f32 v64, v64
    v_cvt_pk_bf16_f32 v47, v62, v63
    v_exp_f32 v65, v65
    s_waitcnt lgkmcnt(0)
    v_mfma_f32_32x32x16_bf16 v[48:63], v[16:19], v[8:11], v[112:127]
    v_exp_f32 v66, v66
    v_cvt_pk_bf16_f32 v40, v64, v65
    v_exp_f32 v67, v67
    v_exp_f32 v68, v68
    v_cvt_pk_bf16_f32 v41, v66, v67
    v_mfma_f32_32x32x16_bf16 v[80:95], v[36:39], v[44:47], v[80:95]
    v_exp_f32 v69, v69
    v_exp_f32 v70, v70
    v_cvt_pk_bf16_f32 v42, v68, v69
    s_mov_b64 exec, s[40:41]
    ds_read_b128 v[24:27], v2 offset:4096
    ds_read_b128 v[28:31], v2 offset:4608
    s_mov_b64 exec, -1
    v_exp_f32 v71, v71
    v_exp_f32 v72, v72
    v_cvt_pk_bf16_f32 v43, v70, v71
    v_exp_f32 v73, v73
    v_exp_f32 v74, v74
    v_mfma_f32_32x32x16_bf16 v[96:111], v[32:35], v[40:43], v[96:111]
    v_cvt_pk_bf16_f32 v44, v72, v73
    v_exp_f32 v75, v75
    v_exp_f32 v76, v76
    v_cvt_pk_bf16_f32 v45, v74, v75
    v_exp_f32 v77, v77
    v_exp_f32 v78, v78
    v_cvt_pk_bf16_f32 v46, v76, v77
    v_exp_f32 v79, v79
    v_exp_f32 v48, v48
    v_cvt_pk_bf16_f32 v47, v78, v79
    v_exp_f32 v49, v49
    v_mfma_f32_32x32x16_bf16 v[64:79], v[16:19], v[12:15], v[128:143]
    v_exp_f32 v50, v50
    v_cvt_pk_bf16_f32 v40, v48, v49
    ds_read_b128 v[20:23], v1 offset:5120
    v_exp_f32 v51, v51
    v_exp_f32 v52, v52
    v_cvt_pk_bf16_f32 v41, v50, v51
    v_mfma_f32_32x32x16_bf16 v[96:111], v[36:39], v[44:47], v[96:111]
    v_exp_f32 v53, v53
    v_exp_f32 v54, v54
    v_cvt_pk_bf16_f32 v42, v52, v53
    v_exp_f32 v55, v55
    v_exp_f32 v56, v56
    v_cvt_pk_bf16_f32 v43, v54, v55
    v_exp_f32 v57, v57
    s_waitcnt lgkmcnt(1)
    v_exp_f32 v58, v58
    v_mfma_f32_32x32x16_bf16 v[80:95], v[24:27], v[40:43], v[80:95]
    v_cvt_pk_bf16_f32 v44, v56, v57
    v_exp_f32 v59, v59
    v_exp_f32 v60, v60
    v_cvt_pk_bf16_f32 v45, v58, v59
    v_exp_f32 v61, v61
    v_exp_f32 v62, v62
    v_cvt_pk_bf16_f32 v46, v60, v61
    v_exp_f32 v63, v63
    v_exp_f32 v64, v64
    v_cvt_pk_bf16_f32 v47, v62, v63
    v_exp_f32 v65, v65
    s_waitcnt lgkmcnt(0)
    v_mfma_f32_32x32x16_bf16 v[48:63], v[20:23], v[8:11], v[112:127]
    v_exp_f32 v66, v66
    v_cvt_pk_bf16_f32 v40, v64, v65
    v_exp_f32 v67, v67
    v_exp_f32 v68, v68
    v_cvt_pk_bf16_f32 v41, v66, v67
    v_mfma_f32_32x32x16_bf16 v[80:95], v[28:31], v[44:47], v[80:95]
    v_exp_f32 v69, v69
    v_exp_f32 v70, v70
    v_cvt_pk_bf16_f32 v42, v68, v69
    s_mov_b64 exec, s[40:41]
    ds_read_b128 v[32:35], v2 offset:5120
    ds_read_b128 v[36:39], v2 offset:5632
    s_mov_b64 exec, -1
    v_exp_f32 v71, v71
    v_exp_f32 v72, v72
    v_cvt_pk_bf16_f32 v43, v70, v71
    v_exp_f32 v73, v73
    v_exp_f32 v74, v74
    v_mfma_f32_32x32x16_bf16 v[96:111], v[24:27], v[40:43], v[96:111]
    v_cvt_pk_bf16_f32 v44, v72, v73
    v_exp_f32 v75, v75
    v_exp_f32 v76, v76
    v_cvt_pk_bf16_f32 v45, v74, v75
    v_exp_f32 v77, v77
    v_exp_f32 v78, v78
    v_cvt_pk_bf16_f32 v46, v76, v77
    v_exp_f32 v79, v79
    v_exp_f32 v48, v48
    v_cvt_pk_bf16_f32 v47, v78, v79
    v_exp_f32 v49, v49
    v_mfma_f32_32x32x16_bf16 v[64:79], v[20:23], v[12:15], v[128:143]
    v_exp_f32 v50, v50
    v_cvt_pk_bf16_f32 v40, v48, v49
    ds_read_b128 v[16:19], v1 offset:6144
    v_exp_f32 v51, v51
    v_exp_f32 v52, v52
    v_cvt_pk_bf16_f32 v41, v50, v51
    v_mfma_f32_32x32x16_bf16 v[96:111], v[28:31], v[44:47], v[96:111]
    v_exp_f32 v53, v53
    v_exp_f32 v54, v54
    v_cvt_pk_bf16_f32 v42, v52, v53
    v_exp_f32 v55, v55
    v_exp_f32 v56, v56
    v_cvt_pk_bf16_f32 v43, v54, v55
    v_exp_f32 v57, v57
    s_waitcnt lgkmcnt(1)
    v_exp_f32 v58, v58
    v_mfma_f32_32x32x16_bf16 v[80:95], v[32:35], v[40:43], v[80:95]
    v_cvt_pk_bf16_f32 v44, v56, v57
    v_exp_f32 v59, v59
    v_exp_f32 v60, v60
    v_cvt_pk_bf16_f32 v45, v58, v59
    v_exp_f32 v61, v61
    v_exp_f32 v62, v62
    v_cvt_pk_bf16_f32 v46, v60, v61
    v_exp_f32 v63, v63
    v_exp_f32 v64, v64
    v_cvt_pk_bf16_f32 v47, v62, v63
    v_exp_f32 v65, v65
    s_waitcnt lgkmcnt(0)
    v_mfma_f32_32x32x16_bf16 v[48:63], v[16:19], v[8:11], v[112:127]
    v_exp_f32 v66, v66
    v_cvt_pk_bf16_f32 v40, v64, v65
    v_exp_f32 v67, v67
    v_exp_f32 v68, v68
    v_cvt_pk_bf16_f32 v41, v66, v67
    v_mfma_f32_32x32x16_bf16 v[80:95], v[36:39], v[44:47], v[80:95]
    v_exp_f32 v69, v69
    v_exp_f32 v70, v70
    v_cvt_pk_bf16_f32 v42, v68, v69
    s_mov_b64 exec, s[40:41]
    ds_read_b128 v[24:27], v2 offset:6144
    ds_read_b128 v[28:31], v2 offset:6656
    s_mov_b64 exec, -1
    v_exp_f32 v71, v71
    v_exp_f32 v72, v72
    v_cvt_pk_bf16_f32 v43, v70, v71
    v_exp_f32 v73, v73
    v_exp_f32 v74, v74
    v_mfma_f32_32x32x16_bf16 v[96:111], v[32:35], v[40:43], v[96:111]
    v_cvt_pk_bf16_f32 v44, v72, v73
    v_exp_f32 v75, v75
    v_exp_f32 v76, v76
    v_cvt_pk_bf16_f32 v45, v74, v75
    v_exp_f32 v77, v77
    v_exp_f32 v78, v78
    v_cvt_pk_bf16_f32 v46, v76, v77
    v_exp_f32 v79, v79
    v_exp_f32 v48, v48
    v_cvt_pk_bf16_f32 v47, v78, v79
    v_exp_f32 v49, v49
    v_mfma_f32_32x32x16_bf16 v[64:79], v[16:19], v[12:15], v[128:143]
    v_exp_f32 v50, v50
    v_cvt_pk_bf16_f32 v40, v48, v49
    ds_read_b128 v[20:23], v1 offset:7168
    v_exp_f32 v51, v51
    v_exp_f32 v52, v52
    v_cvt_pk_bf16_f32 v41, v50, v51
    v_mfma_f32_32x32x16_bf16 v[96:111], v[36:39], v[44:47], v[96:111]
    v_exp_f32 v53, v53
    v_exp_f32 v54, v54
    v_cvt_pk_bf16_f32 v42, v52, v53
    v_exp_f32 v55, v55
    v_exp_f32 v56, v56
    v_cvt_pk_bf16_f32 v43, v54, v55
    v_exp_f32 v57, v57
    s_waitcnt lgkmcnt(1)
    v_exp_f32 v58, v58
    v_mfma_f32_32x32x16_bf16 v[80:95], v[24:27], v[40:43], v[80:95]
    v_cvt_pk_bf16_f32 v44, v56, v57
    v_exp_f32 v59, v59
    v_exp_f32 v60, v60
    v_cvt_pk_bf16_f32 v45, v58, v59
    v_exp_f32 v61, v61
    v_exp_f32 v62, v62
    v_cvt_pk_bf16_f32 v46, v60, v61
    v_exp_f32 v63, v63
    v_exp_f32 v64, v64
    v_cvt_pk_bf16_f32 v47, v62, v63
    v_exp_f32 v65, v65
    s_waitcnt lgkmcnt(0)
    v_mfma_f32_32x32x16_bf16 v[48:63], v[20:23], v[8:11], v[112:127]
    v_exp_f32 v66, v66
    v_cvt_pk_bf16_f32 v40, v64, v65
    v_exp_f32 v67, v67
    v_exp_f32 v68, v68
    v_cvt_pk_bf16_f32 v41, v66, v67
    v_mfma_f32_32x32x16_bf16 v[80:95], v[28:31], v[44:47], v[80:95]
    v_exp_f32 v69, v69
    v_exp_f32 v70, v70
    v_cvt_pk_bf16_f32 v42, v68, v69
    s_mov_b64 exec, s[40:41]
    ds_read_b128 v[32:35], v2 offset:7168
    ds_read_b128 v[36:39], v2 offset:7680
    s_mov_b64 exec, -1
    v_exp_f32 v71, v71
    v_exp_f32 v72, v72
    v_cvt_pk_bf16_f32 v43, v70, v71
    v_exp_f32 v73, v73
    v_exp_f32 v74, v74
    v_mfma_f32_32x32x16_bf16 v[96:111], v[24:27], v[40:43], v[96:111]
    v_cvt_pk_bf16_f32 v44, v72, v73
    v_exp_f32 v75, v75
    v_exp_f32 v76, v76
    v_cvt_pk_bf16_f32 v45, v74, v75
    v_exp_f32 v77, v77
    v_exp_f32 v78, v78
    v_cvt_pk_bf16_f32 v46, v76, v77
    v_exp_f32 v79, v79
    v_exp_f32 v48, v48
    v_cvt_pk_bf16_f32 v47, v78, v79
    v_exp_f32 v49, v49
    v_mfma_f32_32x32x16_bf16 v[64:79], v[20:23], v[12:15], v[128:143]
    v_exp_f32 v50, v50
    v_cvt_pk_bf16_f32 v40, v48, v49
    ds_read_b128 v[16:19], v1 offset:8192
    v_exp_f32 v51, v51
    v_exp_f32 v52, v52
    v_cvt_pk_bf16_f32 v41, v50, v51
    v_mfma_f32_32x32x16_bf16 v[96:111], v[28:31], v[44:47], v[96:111]
    v_exp_f32 v53, v53
    v_exp_f32 v54, v54
    v_cvt_pk_bf16_f32 v42, v52, v53
    v_exp_f32 v55, v55
    v_exp_f32 v56, v56
    v_cvt_pk_bf16_f32 v43, v54, v55
    v_exp_f32 v57, v57
    s_waitcnt lgkmcnt(1)
    v_exp_f32 v58, v58
    v_mfma_f32_32x32x16_bf16 v[80:95], v[32:35], v[40:43], v[80:95]
    v_cvt_pk_bf16_f32 v44, v56, v57
    v_exp_f32 v59, v59
    v_exp_f32 v60, v60
    v_cvt_pk_bf16_f32 v45, v58, v59
    v_exp_f32 v61, v61
    v_exp_f32 v62, v62
    v_cvt_pk_bf16_f32 v46, v60, v61
    v_exp_f32 v63, v63
    v_exp_f32 v64, v64
    v_cvt_pk_bf16_f32 v47, v62, v63
    v_exp_f32 v65, v65
    s_waitcnt lgkmcnt(0)
    v_mfma_f32_32x32x16_bf16 v[48:63], v[16:19], v[8:11], v[112:127]
    v_exp_f32 v66, v66
    v_cvt_pk_bf16_f32 v40, v64, v65
    v_exp_f32 v67, v67
    v_exp_f32 v68, v68
    v_cvt_pk_bf16_f32 v41, v66, v67
    v_mfma_f32_32x32x16_bf16 v[80:95], v[36:39], v[44:47], v[80:95]
    v_exp_f32 v69, v69
    v_exp_f32 v70, v70
    v_cvt_pk_bf16_f32 v42, v68, v69
    s_mov_b64 exec, s[40:41]
    ds_read_b128 v[24:27], v2 offset:8192
    ds_read_b128 v[28:31], v2 offset:8704
    s_mov_b64 exec, -1
    v_exp_f32 v71, v71
    v_exp_f32 v72, v72
    v_cvt_pk_bf16_f32 v43, v70, v71
    v_exp_f32 v73, v73
    v_exp_f32 v74, v74
    v_mfma_f32_32x32x16_bf16 v[96:111], v[32:35], v[40:43], v[96:111]
    v_cvt_pk_bf16_f32 v44, v72, v73
    v_exp_f32 v75, v75
    v_exp_f32 v76, v76
    v_cvt_pk_bf16_f32 v45, v74, v75
    v_exp_f32 v77, v77
    v_exp_f32 v78, v78
    v_cvt_pk_bf16_f32 v46, v76, v77
    v_exp_f32 v79, v79
    v_add_u32 v1, 0x2000, v1
    v_add_u32 v2, 0x2000, v2
    s_sub_u32 s10, s10, 1
    s_cmp_lg_u32 s10, 0
    s_cbranch_scc1 parallel_loop
    v_exp_f32 v48, v48
    v_cvt_pk_bf16_f32 v47, v78, v79
    v_exp_f32 v49, v49
    v_mfma_f32_32x32x16_bf16 v[64:79], v[16:19], v[12:15], v[128:143]
    v_exp_f32 v50, v50
    v_cvt_pk_bf16_f32 v40, v48, v49
    ds_read_b128 v[20:23], v1 offset:1024
    v_exp_f32 v51, v51
    v_exp_f32 v52, v52
    v_cvt_pk_bf16_f32 v41, v50, v51
    v_mfma_f32_32x32x16_bf16 v[96:111], v[36:39], v[44:47], v[96:111]
    v_exp_f32 v53, v53
    v_exp_f32 v54, v54
    v_cvt_pk_bf16_f32 v42, v52, v53
    v_exp_f32 v55, v55
    v_exp_f32 v56, v56
    v_cvt_pk_bf16_f32 v43, v54, v55
    v_exp_f32 v57, v57
    s_waitcnt lgkmcnt(1)
    v_exp_f32 v58, v58
    v_mfma_f32_32x32x16_bf16 v[80:95], v[24:27], v[40:43], v[80:95]
    v_cvt_pk_bf16_f32 v44, v56, v57
    v_exp_f32 v59, v59
    v_exp_f32 v60, v60
    v_cvt_pk_bf16_f32 v45, v58, v59
    v_exp_f32 v61, v61
    v_exp_f32 v62, v62
    v_cvt_pk_bf16_f32 v46, v60, v61
    v_exp_f32 v63, v63
    v_exp_f32 v64, v64
    v_cvt_pk_bf16_f32 v47, v62, v63
    v_exp_f32 v65, v65
    s_waitcnt lgkmcnt(0)
    v_mfma_f32_32x32x16_bf16 v[48:63], v[20:23], v[8:11], v[112:127]
    v_exp_f32 v66, v66
    v_cvt_pk_bf16_f32 v40, v64, v65
    v_exp_f32 v67, v67
    v_exp_f32 v68, v68
    v_cvt_pk_bf16_f32 v41, v66, v67
    v_mfma_f32_32x32x16_bf16 v[80:95], v[28:31], v[44:47], v[80:95]
    v_exp_f32 v69, v69
    v_exp_f32 v70, v70
    v_cvt_pk_bf16_f32 v42, v68, v69
    s_mov_b64 exec, s[40:41]
    ds_read_b128 v[32:35], v2 offset:1024
    ds_read_b128 v[36:39], v2 offset:1536
    s_mov_b64 exec, -1
    v_exp_f32 v71, v71
    v_exp_f32 v72, v72
    v_cvt_pk_bf16_f32 v43, v70, v71
    v_exp_f32 v73, v73
    v_exp_f32 v74, v74
    v_mfma_f32_32x32x16_bf16 v[96:111], v[24:27], v[40:43], v[96:111]
    v_cvt_pk_bf16_f32 v44, v72, v73
    v_exp_f32 v75, v75
    v_exp_f32 v76, v76
    v_cvt_pk_bf16_f32 v45, v74, v75
    v_exp_f32 v77, v77
    v_exp_f32 v78, v78
    v_cvt_pk_bf16_f32 v46, v76, v77
    v_exp_f32 v79, v79
    v_exp_f32 v48, v48
    v_cvt_pk_bf16_f32 v47, v78, v79
    v_exp_f32 v49, v49
    v_mfma_f32_32x32x16_bf16 v[64:79], v[20:23], v[12:15], v[128:143]
    v_exp_f32 v50, v50
    v_cvt_pk_bf16_f32 v40, v48, v49
    ds_read_b128 v[16:19], v1 offset:2048
    v_exp_f32 v51, v51
    v_exp_f32 v52, v52
    v_cvt_pk_bf16_f32 v41, v50, v51
    v_mfma_f32_32x32x16_bf16 v[96:111], v[28:31], v[44:47], v[96:111]
    v_exp_f32 v53, v53
    v_exp_f32 v54, v54
    v_cvt_pk_bf16_f32 v42, v52, v53
    v_exp_f32 v55, v55
    v_exp_f32 v56, v56
    v_cvt_pk_bf16_f32 v43, v54, v55
    v_exp_f32 v57, v57
    s_waitcnt lgkmcnt(1)
    v_exp_f32 v58, v58
    v_mfma_f32_32x32x16_bf16 v[80:95], v[32:35], v[40:43], v[80:95]
    v_cvt_pk_bf16_f32 v44, v56, v57
    v_exp_f32 v59, v59
    v_exp_f32 v60, v60
    v_cvt_pk_bf16_f32 v45, v58, v59
    v_exp_f32 v61, v61
    v_exp_f32 v62, v62
    v_cvt_pk_bf16_f32 v46, v60, v61
    v_exp_f32 v63, v63
    v_exp_f32 v64, v64
    v_cvt_pk_bf16_f32 v47, v62, v63
    v_exp_f32 v65, v65
    s_waitcnt lgkmcnt(0)
    v_mfma_f32_32x32x16_bf16 v[48:63], v[16:19], v[8:11], v[112:127]
    v_exp_f32 v66, v66
    v_cvt_pk_bf16_f32 v40, v64, v65
    v_exp_f32 v67, v67
    v_exp_f32 v68, v68
    v_cvt_pk_bf16_f32 v41, v66, v67
    v_mfma_f32_32x32x16_bf16 v[80:95], v[36:39], v[44:47], v[80:95]
    v_exp_f32 v69, v69
    v_exp_f32 v70, v70
    v_cvt_pk_bf16_f32 v42, v68, v69
    s_mov_b64 exec, s[40:41]
    ds_read_b128 v[24:27], v2 offset:2048
    ds_read_b128 v[28:31], v2 offset:2560
    s_mov_b64 exec, -1
    v_exp_f32 v71, v71
    v_exp_f32 v72, v72
    v_cvt_pk_bf16_f32 v43, v70, v71
    v_exp_f32 v73, v73
    v_exp_f32 v74, v74
    v_mfma_f32_32x32x16_bf16 v[96:111], v[32:35], v[40:43], v[96:111]
    v_cvt_pk_bf16_f32 v44, v72, v73
    v_exp_f32 v75, v75
    v_exp_f32 v76, v76
    v_cvt_pk_bf16_f32 v45, v74, v75
    v_exp_f32 v77, v77
    v_exp_f32 v78, v78
    v_cvt_pk_bf16_f32 v46, v76, v77
    v_exp_f32 v79, v79
    v_exp_f32 v48, v48
    v_cvt_pk_bf16_f32 v47, v78, v79
    v_exp_f32 v49, v49
    v_mfma_f32_32x32x16_bf16 v[64:79], v[16:19], v[12:15], v[128:143]
    v_exp_f32 v50, v50
    v_cvt_pk_bf16_f32 v40, v48, v49
    ds_read_b128 v[20:23], v1 offset:3072
    v_exp_f32 v51, v51
    v_exp_f32 v52, v52
    v_cvt_pk_bf16_f32 v41, v50, v51
    v_mfma_f32_32x32x16_bf16 v[96:111], v[36:39], v[44:47], v[96:111]
    v_exp_f32 v53, v53
    v_exp_f32 v54, v54
    v_cvt_pk_bf16_f32 v42, v52, v53
    v_exp_f32 v55, v55
    v_exp_f32 v56, v56
    v_cvt_pk_bf16_f32 v43, v54, v55
    v_exp_f32 v57, v57
    s_waitcnt lgkmcnt(1)
    v_exp_f32 v58, v58
    v_mfma_f32_32x32x16_bf16 v[80:95], v[24:27], v[40:43], v[80:95]
    v_cvt_pk_bf16_f32 v44, v56, v57
    v_exp_f32 v59, v59
    v_exp_f32 v60, v60
    v_cvt_pk_bf16_f32 v45, v58, v59
    v_exp_f32 v61, v61
    v_exp_f32 v62, v62
    v_cvt_pk_bf16_f32 v46, v60, v61
    v_exp_f32 v63, v63
    v_exp_f32 v64, v64
    v_cvt_pk_bf16_f32 v47, v62, v63
    v_exp_f32 v65, v65
    s_waitcnt lgkmcnt(0)
    v_mfma_f32_32x32x16_bf16 v[48:63], v[20:23], v[8:11], v[112:127]
    v_exp_f32 v66, v66
    v_cvt_pk_bf16_f32 v40, v64, v65
    v_exp_f32 v67, v67
    v_exp_f32 v68, v68
    v_cvt_pk_bf16_f32 v41, v66, v67
    v_mfma_f32_32x32x16_bf16 v[80:95], v[28:31], v[44:47], v[80:95]
    v_exp_f32 v69, v69
    v_exp_f32 v70, v70
    v_cvt_pk_bf16_f32 v42, v68, v69
    s_mov_b64 exec, s[40:41]
    ds_read_b128 v[32:35], v2 offset:3072
    ds_read_b128 v[36:39], v2 offset:3584
    s_mov_b64 exec, -1
    v_exp_f32 v71, v71
    v_exp_f32 v72, v72
    v_cvt_pk_bf16_f32 v43, v70, v71
    v_exp_f32 v73, v73
    v_exp_f32 v74, v74
    v_mfma_f32_32x32x16_bf16 v[96:111], v[24:27], v[40:43], v[96:111]
    v_cvt_pk_bf16_f32 v44, v72, v73
    v_exp_f32 v75, v75
    v_exp_f32 v76, v76
    v_cvt_pk_bf16_f32 v45, v74, v75
    v_exp_f32 v77, v77
    v_exp_f32 v78, v78
    v_cvt_pk_bf16_f32 v46, v76, v77
    v_exp_f32 v79, v79
    v_exp_f32 v48, v48
    v_cvt_pk_bf16_f32 v47, v78, v79
    v_exp_f32 v49, v49
    v_mfma_f32_32x32x16_bf16 v[64:79], v[20:23], v[12:15], v[128:143]
    v_exp_f32 v50, v50
    v_cvt_pk_bf16_f32 v40, v48, v49
    ds_read_b128 v[16:19], v1 offset:4096
    v_exp_f32 v51, v51
    v_exp_f32 v52, v52
    v_cvt_pk_bf16_f32 v41, v50, v51
    v_mfma_f32_32x32x16_bf16 v[96:111], v[28:31], v[44:47], v[96:111]
    v_exp_f32 v53, v53
    v_exp_f32 v54, v54
    v_cvt_pk_bf16_f32 v42, v52, v53
    v_exp_f32 v55, v55
    v_exp_f32 v56, v56
    v_cvt_pk_bf16_f32 v43, v54, v55
    v_exp_f32 v57, v57
    s_waitcnt lgkmcnt(1)
    v_exp_f32 v58, v58
    v_mfma_f32_32x32x16_bf16 v[80:95], v[32:35], v[40:43], v[80:95]
    v_cvt_pk_bf16_f32 v44, v56, v57
    v_exp_f32 v59, v59
    v_exp_f32 v60, v60
    v_cvt_pk_bf16_f32 v45, v58, v59
    v_exp_f32 v61, v61
    v_exp_f32 v62, v62
    v_cvt_pk_bf16_f32 v46, v60, v61
    v_exp_f32 v63, v63
    v_exp_f32 v64, v64
    v_cvt_pk_bf16_f32 v47, v62, v63
    v_exp_f32 v65, v65
    s_waitcnt lgkmcnt(0)
    v_mfma_f32_32x32x16_bf16 v[48:63], v[16:19], v[8:11], v[112:127]
    v_exp_f32 v66, v66
    v_cvt_pk_bf16_f32 v40, v64, v65
    v_exp_f32 v67, v67
    v_exp_f32 v68, v68
    v_cvt_pk_bf16_f32 v41, v66, v67
    v_mfma_f32_32x32x16_bf16 v[80:95], v[36:39], v[44:47], v[80:95]
    v_exp_f32 v69, v69
    v_exp_f32 v70, v70
    v_cvt_pk_bf16_f32 v42, v68, v69
    s_mov_b64 exec, s[40:41]
    ds_read_b128 v[24:27], v2 offset:4096
    ds_read_b128 v[28:31], v2 offset:4608
    s_mov_b64 exec, -1
    v_exp_f32 v71, v71
    v_exp_f32 v72, v72
    v_cvt_pk_bf16_f32 v43, v70, v71
    v_exp_f32 v73, v73
    v_exp_f32 v74, v74
    v_mfma_f32_32x32x16_bf16 v[96:111], v[32:35], v[40:43], v[96:111]
    v_cvt_pk_bf16_f32 v44, v72, v73
    v_exp_f32 v75, v75
    v_exp_f32 v76, v76
    v_cvt_pk_bf16_f32 v45, v74, v75
    v_exp_f32 v77, v77
    v_exp_f32 v78, v78
    v_cvt_pk_bf16_f32 v46, v76, v77
    v_exp_f32 v79, v79
    v_exp_f32 v48, v48
    v_cvt_pk_bf16_f32 v47, v78, v79
    v_exp_f32 v49, v49
    v_mfma_f32_32x32x16_bf16 v[64:79], v[16:19], v[12:15], v[128:143]
    v_exp_f32 v50, v50
    v_cvt_pk_bf16_f32 v40, v48, v49
    ds_read_b128 v[20:23], v1 offset:5120
    v_exp_f32 v51, v51
    v_exp_f32 v52, v52
    v_cvt_pk_bf16_f32 v41, v50, v51
    v_mfma_f32_32x32x16_bf16 v[96:111], v[36:39], v[44:47], v[96:111]
    v_exp_f32 v53, v53
    v_exp_f32 v54, v54
    v_cvt_pk_bf16_f32 v42, v52, v53
    v_exp_f32 v55, v55
    v_exp_f32 v56, v56
    v_cvt_pk_bf16_f32 v43, v54, v55
    v_exp_f32 v57, v57
    s_waitcnt lgkmcnt(1)
    v_exp_f32 v58, v58
    v_mfma_f32_32x32x16_bf16 v[80:95], v[24:27], v[40:43], v[80:95]
    v_cvt_pk_bf16_f32 v44, v56, v57
    v_exp_f32 v59, v59
    v_exp_f32 v60, v60
    v_cvt_pk_bf16_f32 v45, v58, v59
    v_exp_f32 v61, v61
    v_exp_f32 v62, v62
    v_cvt_pk_bf16_f32 v46, v60, v61
    v_exp_f32 v63, v63
    v_exp_f32 v64, v64
    v_cvt_pk_bf16_f32 v47, v62, v63
    v_exp_f32 v65, v65
    s_waitcnt lgkmcnt(0)
    v_mfma_f32_32x32x16_bf16 v[48:63], v[20:23], v[8:11], v[112:127]
    v_exp_f32 v66, v66
    v_cvt_pk_bf16_f32 v40, v64, v65
    v_exp_f32 v67, v67
    v_exp_f32 v68, v68
    v_cvt_pk_bf16_f32 v41, v66, v67
    v_mfma_f32_32x32x16_bf16 v[80:95], v[28:31], v[44:47], v[80:95]
    v_exp_f32 v69, v69
    v_exp_f32 v70, v70
    v_cvt_pk_bf16_f32 v42, v68, v69
    s_mov_b64 exec, s[40:41]
    ds_read_b128 v[32:35], v2 offset:5120
    ds_read_b128 v[36:39], v2 offset:5632
    s_mov_b64 exec, -1
    v_exp_f32 v71, v71
    v_exp_f32 v72, v72
    v_cvt_pk_bf16_f32 v43, v70, v71
    v_exp_f32 v73, v73
    v_exp_f32 v74, v74
    v_mfma_f32_32x32x16_bf16 v[96:111], v[24:27], v[40:43], v[96:111]
    v_cvt_pk_bf16_f32 v44, v72, v73
    v_exp_f32 v75, v75
    v_exp_f32 v76, v76
    v_cvt_pk_bf16_f32 v45, v74, v75
    v_exp_f32 v77, v77
    v_exp_f32 v78, v78
    v_cvt_pk_bf16_f32 v46, v76, v77
    v_exp_f32 v79, v79
    v_exp_f32 v48, v48
    v_cvt_pk_bf16_f32 v47, v78, v79
    v_exp_f32 v49, v49
    v_mfma_f32_32x32x16_bf16 v[64:79], v[20:23], v[12:15], v[128:143]
    v_exp_f32 v50, v50
    v_cvt_pk_bf16_f32 v40, v48, v49
    ds_read_b128 v[16:19], v1 offset:6144
    v_exp_f32 v51, v51
    v_exp_f32 v52, v52
    v_cvt_pk_bf16_f32 v41, v50, v51
    v_mfma_f32_32x32x16_bf16 v[96:111], v[28:31], v[44:47], v[96:111]
    v_exp_f32 v53, v53
    v_exp_f32 v54, v54
    v_cvt_pk_bf16_f32 v42, v52, v53
    v_exp_f32 v55, v55
    v_exp_f32 v56, v56
    v_cvt_pk_bf16_f32 v43, v54, v55
    v_exp_f32 v57, v57
    s_waitcnt lgkmcnt(1)
    v_exp_f32 v58, v58
    v_mfma_f32_32x32x16_bf16 v[80:95], v[32:35], v[40:43], v[80:95]
    v_cvt_pk_bf16_f32 v44, v56, v57
    v_exp_f32 v59, v59
    v_exp_f32 v60, v60
    v_cvt_pk_bf16_f32 v45, v58, v59
    v_exp_f32 v61, v61
    v_exp_f32 v62, v62
    v_cvt_pk_bf16_f32 v46, v60, v61
    v_exp_f32 v63, v63
    v_exp_f32 v64, v64
    v_cvt_pk_bf16_f32 v47, v62, v63
    v_exp_f32 v65, v65
    s_waitcnt lgkmcnt(0)
    v_mfma_f32_32x32x16_bf16 v[48:63], v[16:19], v[8:11], v[112:127]
    v_exp_f32 v66, v66
    v_cvt_pk_bf16_f32 v40, v64, v65
    v_exp_f32 v67, v67
    v_exp_f32 v68, v68
    v_cvt_pk_bf16_f32 v41, v66, v67
    v_mfma_f32_32x32x16_bf16 v[80:95], v[36:39], v[44:47], v[80:95]
    v_exp_f32 v69, v69
    v_exp_f32 v70, v70
    v_cvt_pk_bf16_f32 v42, v68, v69
    s_mov_b64 exec, s[40:41]
    ds_read_b128 v[24:27], v2 offset:6144
    ds_read_b128 v[28:31], v2 offset:6656
    s_mov_b64 exec, -1
    v_exp_f32 v71, v71
    v_exp_f32 v72, v72
    v_cvt_pk_bf16_f32 v43, v70, v71
    v_exp_f32 v73, v73
    v_exp_f32 v74, v74
    v_mfma_f32_32x32x16_bf16 v[96:111], v[32:35], v[40:43], v[96:111]
    v_cvt_pk_bf16_f32 v44, v72, v73
    v_exp_f32 v75, v75
    v_exp_f32 v76, v76
    v_cvt_pk_bf16_f32 v45, v74, v75
    v_exp_f32 v77, v77
    v_exp_f32 v78, v78
    v_cvt_pk_bf16_f32 v46, v76, v77
    v_exp_f32 v79, v79
    v_exp_f32 v48, v48
    v_cvt_pk_bf16_f32 v47, v78, v79
    v_exp_f32 v49, v49
    v_mfma_f32_32x32x16_bf16 v[64:79], v[16:19], v[12:15], v[128:143]
    v_exp_f32 v50, v50
    v_cvt_pk_bf16_f32 v40, v48, v49
    ds_read_b128 v[20:23], v1 offset:7168
    v_exp_f32 v51, v51
    v_exp_f32 v52, v52
    v_cvt_pk_bf16_f32 v41, v50, v51
    v_mfma_f32_32x32x16_bf16 v[96:111], v[36:39], v[44:47], v[96:111]
    v_exp_f32 v53, v53
    v_exp_f32 v54, v54
    v_cvt_pk_bf16_f32 v42, v52, v53
    v_exp_f32 v55, v55
    v_exp_f32 v56, v56
    v_cvt_pk_bf16_f32 v43, v54, v55
    v_exp_f32 v57, v57
    s_waitcnt lgkmcnt(1)
    v_exp_f32 v58, v58
    v_mfma_f32_32x32x16_bf16 v[80:95], v[24:27], v[40:43], v[80:95]
    v_cvt_pk_bf16_f32 v44, v56, v57
    v_exp_f32 v59, v59
    v_exp_f32 v60, v60
    v_cvt_pk_bf16_f32 v45, v58, v59
    v_exp_f32 v61, v61
    v_exp_f32 v62, v62
    v_cvt_pk_bf16_f32 v46, v60, v61
    v_exp_f32 v63, v63
    v_exp_f32 v64, v64
    v_cvt_pk_bf16_f32 v47, v62, v63
    v_exp_f32 v65, v65
    s_waitcnt lgkmcnt(0)
    v_mfma_f32_32x32x16_bf16 v[48:63], v[20:23], v[8:11], v[112:127]
    v_exp_f32 v66, v66
    v_cvt_pk_bf16_f32 v40, v64, v65
    v_exp_f32 v67, v67
    v_exp_f32 v68, v68
    v_cvt_pk_bf16_f32 v41, v66, v67
    v_mfma_f32_32x32x16_bf16 v[80:95], v[28:31], v[44:47], v[80:95]
    v_exp_f32 v69, v69
    v_exp_f32 v70, v70
    v_cvt_pk_bf16_f32 v42, v68, v69
    s_mov_b64 exec, s[40:41]
    ds_read_b128 v[32:35], v2 offset:7168
    ds_read_b128 v[36:39], v2 offset:7680
    s_mov_b64 exec, -1
    v_exp_f32 v71, v71
    v_exp_f32 v72, v72
    v_cvt_pk_bf16_f32 v43, v70, v71
    v_exp_f32 v73, v73
    v_exp_f32 v74, v74
    v_mfma_f32_32x32x16_bf16 v[96:111], v[24:27], v[40:43], v[96:111]
    v_cvt_pk_bf16_f32 v44, v72, v73
    v_exp_f32 v75, v75
    v_exp_f32 v76, v76
    v_cvt_pk_bf16_f32 v45, v74, v75
    v_exp_f32 v77, v77
    v_exp_f32 v78, v78
    v_cvt_pk_bf16_f32 v46, v76, v77
    v_exp_f32 v79, v79
    v_exp_f32 v48, v48
    v_cvt_pk_bf16_f32 v47, v78, v79
    v_exp_f32 v49, v49
    v_mfma_f32_32x32x16_bf16 v[64:79], v[20:23], v[12:15], v[128:143]
    v_exp_f32 v50, v50
    v_cvt_pk_bf16_f32 v40, v48, v49
    v_exp_f32 v51, v51
    v_exp_f32 v52, v52
    v_cvt_pk_bf16_f32 v41, v50, v51
    v_mfma_f32_32x32x16_bf16 v[96:111], v[28:31], v[44:47], v[96:111]
    v_exp_f32 v53, v53
    v_exp_f32 v54, v54
    v_cvt_pk_bf16_f32 v42, v52, v53
    v_exp_f32 v55, v55
    v_exp_f32 v56, v56
    v_cvt_pk_bf16_f32 v43, v54, v55
    v_exp_f32 v57, v57
    s_waitcnt lgkmcnt(0)
    v_exp_f32 v58, v58
    v_mfma_f32_32x32x16_bf16 v[80:95], v[32:35], v[40:43], v[80:95]
    v_cvt_pk_bf16_f32 v44, v56, v57
    v_exp_f32 v59, v59
    v_exp_f32 v60, v60
    v_cvt_pk_bf16_f32 v45, v58, v59
    v_exp_f32 v61, v61
    v_exp_f32 v62, v62
    v_cvt_pk_bf16_f32 v46, v60, v61
    v_exp_f32 v63, v63
    v_exp_f32 v64, v64
    v_cvt_pk_bf16_f32 v47, v62, v63
    v_exp_f32 v65, v65
    v_exp_f32 v66, v66
    v_cvt_pk_bf16_f32 v40, v64, v65
    v_exp_f32 v67, v67
    v_exp_f32 v68, v68
    v_cvt_pk_bf16_f32 v41, v66, v67
    v_mfma_f32_32x32x16_bf16 v[80:95], v[36:39], v[44:47], v[80:95]
    v_exp_f32 v69, v69
    v_exp_f32 v70, v70
    v_cvt_pk_bf16_f32 v42, v68, v69
    v_exp_f32 v71, v71
    v_exp_f32 v72, v72
    v_cvt_pk_bf16_f32 v43, v70, v71
    v_exp_f32 v73, v73
    v_exp_f32 v74, v74
    v_mfma_f32_32x32x16_bf16 v[96:111], v[32:35], v[40:43], v[96:111]
    v_cvt_pk_bf16_f32 v44, v72, v73
    v_exp_f32 v75, v75
    v_exp_f32 v76, v76
    v_cvt_pk_bf16_f32 v45, v74, v75
    v_exp_f32 v77, v77
    v_exp_f32 v78, v78
    v_cvt_pk_bf16_f32 v46, v76, v77
    v_exp_f32 v79, v79
    s_nop 0
    v_cvt_pk_bf16_f32 v47, v78, v79
    s_nop 1
    v_mfma_f32_32x32x16_bf16 v[96:111], v[36:39], v[44:47], v[96:111]
    s_barrier
    s_nop 7
    s_lshl_b32 s11, s17, 1
    s_xor_b32 s12, s16, 1
    s_add_u32 s12, s11, s12
    s_mul_i32 s12, s12, 2304
    s_add_u32 s12, s12, 131072
    s_add_u32 s13, s11, s16
    s_mul_i32 s13, s13, 2304
    s_add_u32 s13, s13, 131072
    v_lshlrev_b32 v5, 2, v0
    v_add_u32 v3, s12, v5
    v_add_u32 v4, s13, v5
    s_cmp_eq_u32 s16, 0
    s_cbranch_scc1 parallel_k0
    ds_write_b32 v3, v80 offset:0
    ds_write_b32 v3, v81 offset:256
    ds_write_b32 v3, v82 offset:512
    ds_write_b32 v3, v83 offset:768
    ds_write_b32 v3, v84 offset:1024
    ds_write_b32 v3, v85 offset:1280
    ds_write_b32 v3, v86 offset:1536
    ds_write_b32 v3, v87 offset:1792
    ds_write_b32 v3, v88 offset:2048
    s_nop 1
    v_mov_b32 v80, v96
    v_mov_b32 v81, v97
    v_mov_b32 v82, v98
    v_mov_b32 v83, v99
    v_mov_b32 v84, v100
    v_mov_b32 v85, v101
    v_mov_b32 v86, v102
    v_mov_b32 v87, v103
    v_mov_b32 v88, v104
    v_mov_b32 v8, v12
    v_mov_b32 v9, v13
    v_mov_b32 v10, v14
    v_mov_b32 v11, v15
    s_branch parallel_k1
parallel_k0:
    ds_write_b32 v3, v96 offset:0
    ds_write_b32 v3, v97 offset:256
    ds_write_b32 v3, v98 offset:512
    ds_write_b32 v3, v99 offset:768
    ds_write_b32 v3, v100 offset:1024
    ds_write_b32 v3, v101 offset:1280
    ds_write_b32 v3, v102 offset:1536
    ds_write_b32 v3, v103 offset:1792
    ds_write_b32 v3, v104 offset:2048
parallel_k1:
    s_waitcnt lgkmcnt(0)
    s_barrier
    ds_read_b32 v48, v4 offset:0
    ds_read_b32 v49, v4 offset:256
    ds_read_b32 v50, v4 offset:512
    ds_read_b32 v51, v4 offset:768
    ds_read_b32 v52, v4 offset:1024
    ds_read_b32 v53, v4 offset:1280
    ds_read_b32 v54, v4 offset:1536
    ds_read_b32 v55, v4 offset:1792
    ds_read_b32 v56, v4 offset:2048
    s_waitcnt lgkmcnt(0)
    v_add_f32 v80, v80, v48
    v_add_f32 v81, v81, v49
    v_add_f32 v82, v82, v50
    v_add_f32 v83, v83, v51
    v_add_f32 v84, v84, v52
    v_add_f32 v85, v85, v53
    v_add_f32 v86, v86, v54
    v_add_f32 v87, v87, v55
    v_add_f32 v88, v88, v56
    s_mov_b32 s10, 0x7b800000
    v_cmp_lt_f32 s[12:13], v88, s10
    v_max3_f32 v3, |v80|, |v81|, |v82|
    v_max3_f32 v3, v3, |v83|, |v84|
    v_max3_f32 v3, v3, |v85|, |v86|
    v_max_f32 v3, v3, |v87|
    s_mov_b32 s10, 0xc800000
    v_cmp_gt_f32 s[14:15], v3, s10
    s_and_b64 s[12:13], s[12:13], s[14:15]
    s_mov_b32 s10, 0x1f8
    v_cmp_class_f32 s[14:15], v80, s10
    s_nop 0
    s_and_b64 s[12:13], s[12:13], s[14:15]
    v_cmp_class_f32 s[14:15], v81, s10
    s_nop 0
    s_and_b64 s[12:13], s[12:13], s[14:15]
    v_cmp_class_f32 s[14:15], v82, s10
    s_nop 0
    s_and_b64 s[12:13], s[12:13], s[14:15]
    v_cmp_class_f32 s[14:15], v83, s10
    s_nop 0
    s_and_b64 s[12:13], s[12:13], s[14:15]
    v_cmp_class_f32 s[14:15], v84, s10
    s_nop 0
    s_and_b64 s[12:13], s[12:13], s[14:15]
    v_cmp_class_f32 s[14:15], v85, s10
    s_nop 0
    s_and_b64 s[12:13], s[12:13], s[14:15]
    v_cmp_class_f32 s[14:15], v86, s10
    s_nop 0
    s_and_b64 s[12:13], s[12:13], s[14:15]
    v_cmp_class_f32 s[14:15], v87, s10
    s_nop 0
    s_and_b64 s[12:13], s[12:13], s[14:15]
    s_cmp_eq_u64 s[12:13], -1
    s_cbranch_scc1 parallel_fin
    v_lshlrev_b32 v1, 4, v0
    v_lshrrev_b32 v3, 5, v0
    v_lshlrev_b32 v3, 8, v3
    v_and_b32 v4, 15, v0
    v_lshlrev_b32 v4, 4, v4
    v_add_u32 v2, v3, v4
    v_mov_b32 v80, 0
    v_mov_b32 v81, 0
    v_mov_b32 v82, 0
    v_mov_b32 v83, 0
    v_mov_b32 v84, 0
    v_mov_b32 v85, 0
    v_mov_b32 v86, 0
    v_mov_b32 v87, 0
    v_mov_b32 v88, 0
    v_mov_b32 v89, 0
    v_mov_b32 v90, 0
    v_mov_b32 v91, 0
    v_mov_b32 v92, 0
    v_mov_b32 v93, 0
    v_mov_b32 v94, 0
    v_mov_b32 v95, 0
    v_mov_b32 v6, 0xff800000
    s_mov_b32 s10, 0
parallel_fb:
    buffer_load_dwordx4 v[16:19], v1, s[28:31], s10 offen
    s_mov_b64 exec, s[40:41]
    buffer_load_dwordx4 v[24:27], v2, s[32:35], s10 offen
    buffer_load_dwordx4 v[28:31], v2, s[32:35], s10 offen offset:512
    s_mov_b64 exec, -1
    s_waitcnt vmcnt(0)
    v_mfma_f32_32x32x16_bf16 v[48:63], v[16:19], v[8:11], 0
    s_nop 7
    s_nop 7
    v_max3_f32 v3, v48, v49, v50
    v_max3_f32 v3, v3, v51, v52
    v_max3_f32 v3, v3, v53, v54
    v_max3_f32 v3, v3, v55, v56
    v_max3_f32 v3, v3, v57, v58
    v_max3_f32 v3, v3, v59, v60
    v_max3_f32 v3, v3, v61, v62
    v_max_f32 v3, v3, v63
    v_mov_b32 v4, v3
    s_nop 1
    v_permlane32_swap_b32 v3, v4
    s_nop 1
    v_max3_f32 v3, v3, v4, v6
    v_sub_f32 v4, v6, v3
    v_exp_f32 v4, v4
    v_mov_b32 v6, v3
    v_mul_f32 v80, v80, v4
    v_mul_f32 v81, v81, v4
    v_mul_f32 v82, v82, v4
    v_mul_f32 v83, v83, v4
    v_mul_f32 v84, v84, v4
    v_mul_f32 v85, v85, v4
    v_mul_f32 v86, v86, v4
    v_mul_f32 v87, v87, v4
    v_mul_f32 v88, v88, v4
    v_sub_f32 v48, v48, v6
    v_sub_f32 v49, v49, v6
    v_sub_f32 v50, v50, v6
    v_sub_f32 v51, v51, v6
    v_sub_f32 v52, v52, v6
    v_sub_f32 v53, v53, v6
    v_sub_f32 v54, v54, v6
    v_sub_f32 v55, v55, v6
    v_sub_f32 v56, v56, v6
    v_sub_f32 v57, v57, v6
    v_sub_f32 v58, v58, v6
    v_sub_f32 v59, v59, v6
    v_sub_f32 v60, v60, v6
    v_sub_f32 v61, v61, v6
    v_sub_f32 v62, v62, v6
    v_sub_f32 v63, v63, v6
    v_exp_f32 v48, v48
    v_exp_f32 v49, v49
    v_exp_f32 v50, v50
    v_exp_f32 v51, v51
    v_exp_f32 v52, v52
    v_exp_f32 v53, v53
    v_exp_f32 v54, v54
    v_exp_f32 v55, v55
    v_exp_f32 v56, v56
    v_exp_f32 v57, v57
    v_exp_f32 v58, v58
    v_exp_f32 v59, v59
    v_exp_f32 v60, v60
    v_exp_f32 v61, v61
    v_exp_f32 v62, v62
    v_exp_f32 v63, v63
    s_nop 0
    v_cvt_pk_bf16_f32 v40, v48, v49
    v_cvt_pk_bf16_f32 v41, v50, v51
    v_cvt_pk_bf16_f32 v42, v52, v53
    v_cvt_pk_bf16_f32 v43, v54, v55
    v_cvt_pk_bf16_f32 v44, v56, v57
    v_cvt_pk_bf16_f32 v45, v58, v59
    v_cvt_pk_bf16_f32 v46, v60, v61
    v_cvt_pk_bf16_f32 v47, v62, v63
    s_nop 1
    v_mfma_f32_32x32x16_bf16 v[80:95], v[24:27], v[40:43], v[80:95]
    v_mfma_f32_32x32x16_bf16 v[80:95], v[28:31], v[44:47], v[80:95]
    s_nop 7
    s_nop 7
    s_add_u32 s10, s10, 1024
    s_cmp_lt_u32 s10, 65536
    s_cbranch_scc1 parallel_fb
parallel_fin:
    v_rcp_f32 v3, v88
    s_add_u32 s10, s23, s16
    s_mul_i32 s10, s10, 147456
    s_lshl_b32 s11, s21, 10
    v_mul_f32 v80, v80, v3
    v_mul_f32 v81, v81, v3
    v_mul_f32 v82, v82, v3
    v_mul_f32 v83, v83, v3
    v_mul_f32 v84, v84, v3
    v_mul_f32 v85, v85, v3
    v_mul_f32 v86, v86, v3
    v_mul_f32 v87, v87, v3
    s_add_u32 s10, s10, s11
    v_cvt_pk_bf16_f32 v40, v80, v81
    v_cvt_pk_bf16_f32 v41, v82, v83
    v_cvt_pk_bf16_f32 v42, v84, v85
    v_cvt_pk_bf16_f32 v43, v86, v87
    v_lshlrev_b32 v4, 4, v0
    buffer_store_dwordx4 v[40:43], v4, s[36:39], s10 offen sc1
    s_waitcnt vmcnt(0)
    s_barrier
    s_endpgm
parallel_p2gemm_poll:
    s_and_b32 s21, s87, 7
    s_lshl_b32 s21, s21, 2
    s_bfe_u32 s3, s87, 0x20003
    s_add_u32 s21, s21, s3
    s_lshr_b32 s22, s87, 5
    s_lshl_b32 s6, s21, 16
    s_add_u32 s8, s84, s6
    s_addc_u32 s9, s85, 0
    s_sub_u32 s16, s86, 8
    s_lshr_b32 s17, s21, 3
    s_lshl_b32 s11, s22, 2
    s_add_u32 s17, s17, s11
    s_and_b32 s18, s21, 7
    s_add_u32 s48, s84, 18931712
    s_addc_u32 s49, s85, 0
    s_mov_b32 s50, 24576
    s_mov_b32 s51, 0x20000
    v_mov_b32 v10, 0
    s_lshr_b32 s11, s21, 4
    s_mul_i32 s11, s11, 32
    s_lshr_b32 s12, s87, 3
    s_lshl_b32 s12, s12, 2
    s_and_b32 s13, s87, 3
    s_add_u32 s12, s12, s13
    s_and_b32 s12, s12, 31
    s_add_u32 s11, s11, s12
    s_lshl_b32 s14, s11, 7
    s_add_u32 s32, s8, 2097152
    s_addc_u32 s33, s9, 0
    s_mov_b32 s34, 65536
    s_mov_b32 s35, 0x20000
    s_add_u32 s36, s8, 4194304
    s_addc_u32 s37, s9, 0
    s_mov_b32 s38, 65536
    s_mov_b32 s39, 0x20000
    v_lshlrev_b32 v6, 4, v0
    s_lshl_b32 s10, s16, 10
    s_mov_b32 s52, s8
    s_mov_b32 s53, s9
    s_mov_b32 s54, 65536
    s_mov_b32 s55, 0x20000
    s_lshl_b32 s15, s22, 3
    s_lshl_b32 s12, s16, 1
    s_add_u32 s15, s15, s12
    s_lshl_b32 s15, s15, 10
    s_lshl_b32 s12, s12, 10
    s_add_u32 s12, s12, 131072
    s_cmp_lg_u32 s16, 0
    s_cbranch_scc1 parallel_bp_6
parallel_pl_7:
    buffer_load_dword v5, v10, s[48:51], s14 offen sc1
    s_waitcnt vmcnt(0)
    v_readfirstlane_b32 s13, v5
    s_nop 3
    s_cmp_ge_u32 s13, 64
    s_cbranch_scc1 parallel_pk_8
    s_sleep 2
    s_branch parallel_pl_7
parallel_pk_8:
parallel_bp_6:
    s_barrier
    s_add_u32 s24, s84, 8388608
    s_addc_u32 s25, s85, 0
    s_mov_b32 s26, 9437184
    s_mov_b32 s27, 0x20000
    s_mov_b32 s28, s76
    s_mov_b32 s29, s77
    s_mov_b32 s30, 1835008
    s_mov_b32 s31, 0x20000
    v_lshrrev_b32 v1, 3, v0
    v_and_b32 v2, 7, v0
    v_bfe_u32 v3, v0, 4, 1
    v_lshlrev_b32 v3, 2, v3
    v_xor_b32 v2, v2, v3
    v_lshlrev_b32 v2, 4, v2
    v_lshl_add_u32 v7, v1, 10, v2
    s_mul_i32 s45, s16, 6144
    s_add_u32 s45, s45, 131072
    v_and_b32 v1, 15, v0
    v_lshrrev_b32 v1, 2, v1
    v_lshrrev_b32 v2, 5, v0
    v_lshl_add_u32 v2, v2, 2, v1
    v_lshlrev_b32 v2, 7, v2
    v_lshrrev_b32 v1, 1, v1
    v_lshl_add_u32 v2, v1, 6, v2
    v_bfe_u32 v1, v0, 4, 1
    v_lshl_add_u32 v2, v1, 5, v2
    v_and_b32 v1, 3, v0
    v_lshl_add_u32 v2, v1, 3, v2
    s_and_b32 s11, s16, 1
    s_lshl_b32 s11, s11, 6
    v_xor_b32 v11, s11, v2
    v_add_u32 v8, s45, v11
    v_xor_b32 v2, 64, v11
    v_add_u32 v9, s45, v2
    s_mul_i32 s19, s17, 294912
    s_mul_i32 s11, s16, 28672
    s_add_u32 s19, s19, s11
    s_add_u32 s19, s19, 32768
    s_add_u32 s42, s19, 147456
    s_cmp_ge_u32 s16, 2
    s_cselect_b32 s11, s42, s19
    s_cselect_b32 s42, s19, s42
    s_mov_b32 s19, s11
    s_mul_i32 s43, s16, 458752
    s_lshl_b32 s11, s18, 7
    s_add_u32 s43, s43, s11
    s_add_u32 s11, s10, 4096
    s_mov_b32 m0, s11
    s_add_u32 s12, s11, 65536
    buffer_load_dwordx4 v6, s[32:35], s11 offen lds
    s_mov_b32 m0, s12
    s_nop 0
    buffer_load_dwordx4 v6, s[36:39], s11 offen lds
    s_add_u32 s11, s10, 36864
    s_mov_b32 m0, s11
    s_add_u32 s12, s11, 65536
    buffer_load_dwordx4 v6, s[32:35], s11 offen lds
    s_mov_b32 m0, s12
    s_nop 0
    buffer_load_dwordx4 v6, s[36:39], s11 offen lds
    s_barrier
    s_add_u32 s11, s10, 8192
    s_mov_b32 m0, s11
    s_add_u32 s12, s11, 65536
    buffer_load_dwordx4 v6, s[32:35], s11 offen lds
    s_mov_b32 m0, s12
    s_nop 0
    buffer_load_dwordx4 v6, s[36:39], s11 offen lds
    s_add_u32 s11, s10, 40960
    s_mov_b32 m0, s11
    s_add_u32 s12, s11, 65536
    buffer_load_dwordx4 v6, s[32:35], s11 offen lds
    s_mov_b32 m0, s12
    s_nop 0
    buffer_load_dwordx4 v6, s[36:39], s11 offen lds
    s_add_u32 s11, s10, 12288
    s_mov_b32 m0, s11
    s_add_u32 s12, s11, 65536
    buffer_load_dwordx4 v6, s[32:35], s11 offen lds
    s_mov_b32 m0, s12
    s_nop 0
    buffer_load_dwordx4 v6, s[36:39], s11 offen lds
    s_add_u32 s11, s10, 45056
    s_mov_b32 m0, s11
    s_add_u32 s12, s11, 65536
    buffer_load_dwordx4 v6, s[32:35], s11 offen lds
    s_mov_b32 m0, s12
    s_nop 0
    buffer_load_dwordx4 v6, s[36:39], s11 offen lds
    s_add_u32 s11, s10, 16384
    s_mov_b32 m0, s11
    s_add_u32 s12, s11, 65536
    buffer_load_dwordx4 v6, s[32:35], s11 offen lds
    s_mov_b32 m0, s12
    s_nop 0
    buffer_load_dwordx4 v6, s[36:39], s11 offen lds
    s_add_u32 s11, s10, 49152
    s_mov_b32 m0, s11
    s_add_u32 s12, s11, 65536
    buffer_load_dwordx4 v6, s[32:35], s11 offen lds
    s_mov_b32 m0, s12
    s_nop 0
    buffer_load_dwordx4 v6, s[36:39], s11 offen lds
    s_add_u32 s11, s10, 20480
    s_mov_b32 m0, s11
    s_add_u32 s12, s11, 65536
    buffer_load_dwordx4 v6, s[32:35], s11 offen lds
    s_mov_b32 m0, s12
    s_nop 0
    buffer_load_dwordx4 v6, s[36:39], s11 offen lds
    s_add_u32 s11, s10, 53248
    s_mov_b32 m0, s11
    s_add_u32 s12, s11, 65536
    buffer_load_dwordx4 v6, s[32:35], s11 offen lds
    s_mov_b32 m0, s12
    s_nop 0
    buffer_load_dwordx4 v6, s[36:39], s11 offen lds
    s_add_u32 s11, s10, 24576
    s_mov_b32 m0, s11
    s_add_u32 s12, s11, 65536
    buffer_load_dwordx4 v6, s[32:35], s11 offen lds
    s_mov_b32 m0, s12
    s_nop 0
    buffer_load_dwordx4 v6, s[36:39], s11 offen lds
    s_add_u32 s11, s10, 57344
    s_mov_b32 m0, s11
    s_add_u32 s12, s11, 65536
    buffer_load_dwordx4 v6, s[32:35], s11 offen lds
    s_mov_b32 m0, s12
    s_nop 0
    buffer_load_dwordx4 v6, s[36:39], s11 offen lds
    s_add_u32 s11, s10, 28672
    s_mov_b32 m0, s11
    s_add_u32 s12, s11, 65536
    buffer_load_dwordx4 v6, s[32:35], s11 offen lds
    s_mov_b32 m0, s12
    s_nop 0
    buffer_load_dwordx4 v6, s[36:39], s11 offen lds
    s_add_u32 s11, s10, 61440
    s_mov_b32 m0, s11
    s_add_u32 s12, s11, 65536
    buffer_load_dwordx4 v6, s[32:35], s11 offen lds
    s_mov_b32 m0, s12
    s_nop 0
    buffer_load_dwordx4 v6, s[36:39], s11 offen lds
    v_mov_b32 v16, 0
    v_mov_b32 v17, 0
    v_mov_b32 v18, 0
    v_mov_b32 v19, 0
    v_mov_b32 v20, 0
    v_mov_b32 v21, 0
    v_mov_b32 v22, 0
    v_mov_b32 v23, 0
    v_mov_b32 v24, 0
    v_mov_b32 v25, 0
    v_mov_b32 v26, 0
    v_mov_b32 v27, 0
    v_mov_b32 v28, 0
    v_mov_b32 v29, 0
    v_mov_b32 v30, 0
    v_mov_b32 v31, 0
    v_mov_b32 v32, 0
    v_mov_b32 v33, 0
    v_mov_b32 v34, 0
    v_mov_b32 v35, 0
    v_mov_b32 v36, 0
    v_mov_b32 v37, 0
    v_mov_b32 v38, 0
    v_mov_b32 v39, 0
    v_mov_b32 v40, 0
    v_mov_b32 v41, 0
    v_mov_b32 v42, 0
    v_mov_b32 v43, 0
    v_mov_b32 v44, 0
    v_mov_b32 v45, 0
    v_mov_b32 v46, 0
    v_mov_b32 v47, 0
    v_mov_b32 v48, 0
    v_mov_b32 v49, 0
    v_mov_b32 v50, 0
    v_mov_b32 v51, 0
    v_mov_b32 v52, 0
    v_mov_b32 v53, 0
    v_mov_b32 v54, 0
    v_mov_b32 v55, 0
    v_mov_b32 v56, 0
    v_mov_b32 v57, 0
    v_mov_b32 v58, 0
    v_mov_b32 v59, 0
    v_mov_b32 v60, 0
    v_mov_b32 v61, 0
    v_mov_b32 v62, 0
    v_mov_b32 v63, 0
    v_mov_b32 v64, 0
    v_mov_b32 v65, 0
    v_mov_b32 v66, 0
    v_mov_b32 v67, 0
    v_mov_b32 v68, 0
    v_mov_b32 v69, 0
    v_mov_b32 v70, 0
    v_mov_b32 v71, 0
    v_mov_b32 v72, 0
    v_mov_b32 v73, 0
    v_mov_b32 v74, 0
    v_mov_b32 v75, 0
    v_mov_b32 v76, 0
    v_mov_b32 v77, 0
    v_mov_b32 v78, 0
    v_mov_b32 v79, 0
    s_waitcnt vmcnt(0)
    s_barrier
    s_lshr_b32 s11, s17, 1
    s_mul_i32 s11, s11, 2
    s_and_b32 s12, s17, 1
    s_lshl_b32 s12, s12, 3
    s_add_u32 s12, s12, s18
    s_and_b32 s12, s12, 1
    s_add_u32 s11, s11, s12
    s_lshl_b32 s11, s11, 7
    s_add_u32 s11, s11, 8192
    v_mov_b32 v2, 155684
    s_cmp_lg_u32 s16, 0
    s_cbranch_scc1 parallel_sw_10
parallel_pl_12:
    buffer_load_dword v5, v10, s[48:51], s11 offen sc1
    s_waitcnt vmcnt(0)
    v_readfirstlane_b32 s13, v5
    s_nop 3
    s_cmp_ge_u32 s13, 7
    s_cbranch_scc1 parallel_pk_13
    s_sleep 4
    s_branch parallel_pl_12
parallel_pk_13:
    v_mov_b32 v1, 1
    ds_write_b32 v2, v1
    s_branch parallel_sd_11
parallel_sw_10:
    ds_read_b32 v1, v2
    s_waitcnt lgkmcnt(0)
    v_readfirstlane_b32 s13, v1
    s_nop 3
    s_cmp_lg_u32 s13, 0
    s_cbranch_scc1 parallel_sd_11
    s_sleep 1
    s_branch parallel_sw_10
parallel_sd_11:
    buffer_load_dwordx4 v[96:99], v6, s[24:27], s19 offen
    buffer_load_dwordx4 v[100:103], v6, s[24:27], s42 offen
    s_add_u32 s19, s19, 1024
    s_add_u32 s42, s42, 1024
    buffer_load_dwordx4 v[104:107], v6, s[24:27], s19 offen
    buffer_load_dwordx4 v[108:111], v6, s[24:27], s42 offen
    s_add_u32 s19, s19, 1024
    s_add_u32 s42, s42, 1024
    buffer_load_dwordx4 v[112:115], v6, s[24:27], s19 offen
    buffer_load_dwordx4 v[116:119], v6, s[24:27], s42 offen
    s_add_u32 s19, s19, 1024
    s_add_u32 s42, s42, 1024
    buffer_load_dwordx4 v[120:123], v6, s[24:27], s19 offen
    buffer_load_dwordx4 v[124:127], v6, s[24:27], s42 offen
    s_add_u32 s19, s19, 1024
    s_add_u32 s42, s42, 1024
    s_add_u32 m0, s45, 0
    s_nop 0
    buffer_load_dwordx4 v7, s[28:31], s43 offen lds
    s_add_u32 m0, s45, 1024
    s_add_u32 s43, s43, 8192
    buffer_load_dwordx4 v7, s[28:31], s43 offen lds
    s_add_u32 s43, s43, 8192
    buffer_load_dwordx4 v[128:131], v6, s[24:27], s19 offen
    buffer_load_dwordx4 v[132:135], v6, s[24:27], s42 offen
    s_add_u32 s19, s19, 1024
    s_add_u32 s42, s42, 1024
    s_add_u32 m0, s45, 2048
    s_nop 0
    buffer_load_dwordx4 v7, s[28:31], s43 offen lds
    s_add_u32 m0, s45, 3072
    s_add_u32 s43, s43, 8192
    buffer_load_dwordx4 v7, s[28:31], s43 offen lds
    s_add_u32 s43, s43, 8192
    buffer_load_dwordx4 v[136:139], v6, s[24:27], s19 offen
    buffer_load_dwordx4 v[140:143], v6, s[24:27], s42 offen
    s_add_u32 s19, s19, 1024
    s_add_u32 s42, s42, 1024
    s_add_u32 m0, s45, 4096
    s_nop 0
    buffer_load_dwordx4 v7, s[28:31], s43 offen lds
    s_add_u32 m0, s45, 5120
    s_add_u32 s43, s43, 8192
    buffer_load_dwordx4 v7, s[28:31], s43 offen lds
    s_add_u32 s43, s43, 8192
    s_waitcnt vmcnt(8)
    ds_read_b64_tr_b16 v[80:81], v8 offset:0
    ds_read_b64_tr_b16 v[82:83], v8 offset:1024
    ds_read_b64_tr_b16 v[84:85], v9 offset:0
    ds_read_b64_tr_b16 v[86:87], v9 offset:1024
    s_mov_b32 s10, 3
parallel_gloop:
    s_waitcnt vmcnt(4)
    ds_read_b64_tr_b16 v[88:89], v8 offset:2048
    ds_read_b64_tr_b16 v[90:91], v8 offset:3072
    ds_read_b64_tr_b16 v[92:93], v9 offset:2048
    ds_read_b64_tr_b16 v[94:95], v9 offset:3072
    s_waitcnt lgkmcnt(4)
    v_mfma_f32_32x32x16_bf16 v[16:31], v[80:83], v[96:99], v[16:31]
    v_mfma_f32_32x32x16_bf16 v[32:47], v[84:87], v[96:99], v[32:47]
    v_mfma_f32_32x32x16_bf16 v[48:63], v[80:83], v[100:103], v[48:63]
    v_mfma_f32_32x32x16_bf16 v[64:79], v[84:87], v[100:103], v[64:79]
    buffer_load_dwordx4 v[96:99], v6, s[24:27], s19 offen
    buffer_load_dwordx4 v[100:103], v6, s[24:27], s42 offen
    s_add_u32 s19, s19, 1024
    s_add_u32 s42, s42, 1024
    s_add_u32 m0, s45, 0
    s_nop 0
    buffer_load_dwordx4 v7, s[28:31], s43 offen lds
    s_add_u32 m0, s45, 1024
    s_add_u32 s43, s43, 8192
    buffer_load_dwordx4 v7, s[28:31], s43 offen lds
    s_add_u32 s43, s43, 8192
    s_waitcnt vmcnt(4)
    ds_read_b64_tr_b16 v[80:81], v8 offset:4096
    ds_read_b64_tr_b16 v[82:83], v8 offset:5120
    ds_read_b64_tr_b16 v[84:85], v9 offset:4096
    ds_read_b64_tr_b16 v[86:87], v9 offset:5120
    s_waitcnt lgkmcnt(4)
    v_mfma_f32_32x32x16_bf16 v[16:31], v[88:91], v[104:107], v[16:31]
    v_mfma_f32_32x32x16_bf16 v[32:47], v[92:95], v[104:107], v[32:47]
    v_mfma_f32_32x32x16_bf16 v[48:63], v[88:91], v[108:111], v[48:63]
    v_mfma_f32_32x32x16_bf16 v[64:79], v[92:95], v[108:111], v[64:79]
    buffer_load_dwordx4 v[104:107], v6, s[24:27], s19 offen
    buffer_load_dwordx4 v[108:111], v6, s[24:27], s42 offen
    s_add_u32 s19, s19, 1024
    s_add_u32 s42, s42, 1024
    s_add_u32 m0, s45, 2048
    s_nop 0
    buffer_load_dwordx4 v7, s[28:31], s43 offen lds
    s_add_u32 m0, s45, 3072
    s_add_u32 s43, s43, 8192
    buffer_load_dwordx4 v7, s[28:31], s43 offen lds
    s_add_u32 s43, s43, 8192
    s_waitcnt vmcnt(4)
    ds_read_b64_tr_b16 v[88:89], v8 offset:0
    ds_read_b64_tr_b16 v[90:91], v8 offset:1024
    ds_read_b64_tr_b16 v[92:93], v9 offset:0
    ds_read_b64_tr_b16 v[94:95], v9 offset:1024
    s_waitcnt lgkmcnt(4)
    v_mfma_f32_32x32x16_bf16 v[16:31], v[80:83], v[112:115], v[16:31]
    v_mfma_f32_32x32x16_bf16 v[32:47], v[84:87], v[112:115], v[32:47]
    v_mfma_f32_32x32x16_bf16 v[48:63], v[80:83], v[116:119], v[48:63]
    v_mfma_f32_32x32x16_bf16 v[64:79], v[84:87], v[116:119], v[64:79]
    buffer_load_dwordx4 v[112:115], v6, s[24:27], s19 offen
    buffer_load_dwordx4 v[116:119], v6, s[24:27], s42 offen
    s_add_u32 s19, s19, 1024
    s_add_u32 s42, s42, 1024
    s_add_u32 m0, s45, 4096
    s_nop 0
    buffer_load_dwordx4 v7, s[28:31], s43 offen lds
    s_add_u32 m0, s45, 5120
    s_add_u32 s43, s43, 8192
    buffer_load_dwordx4 v7, s[28:31], s43 offen lds
    s_add_u32 s43, s43, 8192
    s_waitcnt vmcnt(4)
    ds_read_b64_tr_b16 v[80:81], v8 offset:2048
    ds_read_b64_tr_b16 v[82:83], v8 offset:3072
    ds_read_b64_tr_b16 v[84:85], v9 offset:2048
    ds_read_b64_tr_b16 v[86:87], v9 offset:3072
    s_waitcnt lgkmcnt(4)
    v_mfma_f32_32x32x16_bf16 v[16:31], v[88:91], v[120:123], v[16:31]
    v_mfma_f32_32x32x16_bf16 v[32:47], v[92:95], v[120:123], v[32:47]
    v_mfma_f32_32x32x16_bf16 v[48:63], v[88:91], v[124:127], v[48:63]
    v_mfma_f32_32x32x16_bf16 v[64:79], v[92:95], v[124:127], v[64:79]
    buffer_load_dwordx4 v[120:123], v6, s[24:27], s19 offen
    buffer_load_dwordx4 v[124:127], v6, s[24:27], s42 offen
    s_add_u32 s19, s19, 1024
    s_add_u32 s42, s42, 1024
    s_add_u32 m0, s45, 0
    s_nop 0
    buffer_load_dwordx4 v7, s[28:31], s43 offen lds
    s_add_u32 m0, s45, 1024
    s_add_u32 s43, s43, 8192
    buffer_load_dwordx4 v7, s[28:31], s43 offen lds
    s_add_u32 s43, s43, 8192
    s_waitcnt vmcnt(4)
    ds_read_b64_tr_b16 v[88:89], v8 offset:4096
    ds_read_b64_tr_b16 v[90:91], v8 offset:5120
    ds_read_b64_tr_b16 v[92:93], v9 offset:4096
    ds_read_b64_tr_b16 v[94:95], v9 offset:5120
    s_waitcnt lgkmcnt(4)
    v_mfma_f32_32x32x16_bf16 v[16:31], v[80:83], v[128:131], v[16:31]
    v_mfma_f32_32x32x16_bf16 v[32:47], v[84:87], v[128:131], v[32:47]
    v_mfma_f32_32x32x16_bf16 v[48:63], v[80:83], v[132:135], v[48:63]
    v_mfma_f32_32x32x16_bf16 v[64:79], v[84:87], v[132:135], v[64:79]
    buffer_load_dwordx4 v[128:131], v6, s[24:27], s19 offen
    buffer_load_dwordx4 v[132:135], v6, s[24:27], s42 offen
    s_add_u32 s19, s19, 1024
    s_add_u32 s42, s42, 1024
    s_add_u32 m0, s45, 2048
    s_nop 0
    buffer_load_dwordx4 v7, s[28:31], s43 offen lds
    s_add_u32 m0, s45, 3072
    s_add_u32 s43, s43, 8192
    buffer_load_dwordx4 v7, s[28:31], s43 offen lds
    s_add_u32 s43, s43, 8192
    s_waitcnt vmcnt(4)
    ds_read_b64_tr_b16 v[80:81], v8 offset:0
    ds_read_b64_tr_b16 v[82:83], v8 offset:1024
    ds_read_b64_tr_b16 v[84:85], v9 offset:0
    ds_read_b64_tr_b16 v[86:87], v9 offset:1024
    s_waitcnt lgkmcnt(4)
    v_mfma_f32_32x32x16_bf16 v[16:31], v[88:91], v[136:139], v[16:31]
    v_mfma_f32_32x32x16_bf16 v[32:47], v[92:95], v[136:139], v[32:47]
    v_mfma_f32_32x32x16_bf16 v[48:63], v[88:91], v[140:143], v[48:63]
    v_mfma_f32_32x32x16_bf16 v[64:79], v[92:95], v[140:143], v[64:79]
    buffer_load_dwordx4 v[136:139], v6, s[24:27], s19 offen
    buffer_load_dwordx4 v[140:143], v6, s[24:27], s42 offen
    s_add_u32 s19, s19, 1024
    s_add_u32 s42, s42, 1024
    s_add_u32 m0, s45, 4096
    s_nop 0
    buffer_load_dwordx4 v7, s[28:31], s43 offen lds
    s_add_u32 m0, s45, 5120
    s_add_u32 s43, s43, 8192
    buffer_load_dwordx4 v7, s[28:31], s43 offen lds
    s_add_u32 s43, s43, 8192
    s_sub_u32 s10, s10, 1
    s_cmp_lg_u32 s10, 0
    s_cbranch_scc1 parallel_gloop
    s_waitcnt vmcnt(4)
    ds_read_b64_tr_b16 v[88:89], v8 offset:2048
    ds_read_b64_tr_b16 v[90:91], v8 offset:3072
    ds_read_b64_tr_b16 v[92:93], v9 offset:2048
    ds_read_b64_tr_b16 v[94:95], v9 offset:3072
    s_waitcnt lgkmcnt(4)
    v_mfma_f32_32x32x16_bf16 v[16:31], v[80:83], v[96:99], v[16:31]
    v_mfma_f32_32x32x16_bf16 v[32:47], v[84:87], v[96:99], v[32:47]
    v_mfma_f32_32x32x16_bf16 v[48:63], v[80:83], v[100:103], v[48:63]
    v_mfma_f32_32x32x16_bf16 v[64:79], v[84:87], v[100:103], v[64:79]
    buffer_load_dwordx4 v[96:99], v6, s[24:27], s19 offen
    buffer_load_dwordx4 v[100:103], v6, s[24:27], s42 offen
    s_add_u32 s19, s19, 1024
    s_add_u32 s42, s42, 1024
    s_add_u32 m0, s45, 0
    s_nop 0
    buffer_load_dwordx4 v7, s[28:31], s43 offen lds
    s_add_u32 m0, s45, 1024
    s_add_u32 s43, s43, 8192
    buffer_load_dwordx4 v7, s[28:31], s43 offen lds
    s_add_u32 s43, s43, 8192
    s_waitcnt vmcnt(4)
    ds_read_b64_tr_b16 v[80:81], v8 offset:4096
    ds_read_b64_tr_b16 v[82:83], v8 offset:5120
    ds_read_b64_tr_b16 v[84:85], v9 offset:4096
    ds_read_b64_tr_b16 v[86:87], v9 offset:5120
    s_waitcnt lgkmcnt(4)
    v_mfma_f32_32x32x16_bf16 v[16:31], v[88:91], v[104:107], v[16:31]
    v_mfma_f32_32x32x16_bf16 v[32:47], v[92:95], v[104:107], v[32:47]
    v_mfma_f32_32x32x16_bf16 v[48:63], v[88:91], v[108:111], v[48:63]
    v_mfma_f32_32x32x16_bf16 v[64:79], v[92:95], v[108:111], v[64:79]
    buffer_load_dwordx4 v[104:107], v6, s[24:27], s19 offen
    buffer_load_dwordx4 v[108:111], v6, s[24:27], s42 offen
    s_add_u32 s19, s19, 1024
    s_add_u32 s42, s42, 1024
    s_add_u32 m0, s45, 2048
    s_nop 0
    buffer_load_dwordx4 v7, s[28:31], s43 offen lds
    s_add_u32 m0, s45, 3072
    s_add_u32 s43, s43, 8192
    buffer_load_dwordx4 v7, s[28:31], s43 offen lds
    s_add_u32 s43, s43, 8192
    s_waitcnt vmcnt(4)
    ds_read_b64_tr_b16 v[88:89], v8 offset:0
    ds_read_b64_tr_b16 v[90:91], v8 offset:1024
    ds_read_b64_tr_b16 v[92:93], v9 offset:0
    ds_read_b64_tr_b16 v[94:95], v9 offset:1024
    s_waitcnt lgkmcnt(4)
    v_mfma_f32_32x32x16_bf16 v[16:31], v[80:83], v[112:115], v[16:31]
    v_mfma_f32_32x32x16_bf16 v[32:47], v[84:87], v[112:115], v[32:47]
    v_mfma_f32_32x32x16_bf16 v[48:63], v[80:83], v[116:119], v[48:63]
    v_mfma_f32_32x32x16_bf16 v[64:79], v[84:87], v[116:119], v[64:79]
    buffer_load_dwordx4 v[112:115], v6, s[24:27], s19 offen
    buffer_load_dwordx4 v[116:119], v6, s[24:27], s42 offen
    s_add_u32 s19, s19, 1024
    s_add_u32 s42, s42, 1024
    s_add_u32 m0, s45, 4096
    s_nop 0
    buffer_load_dwordx4 v7, s[28:31], s43 offen lds
    s_add_u32 m0, s45, 5120
    s_add_u32 s43, s43, 8192
    buffer_load_dwordx4 v7, s[28:31], s43 offen lds
    s_add_u32 s43, s43, 8192
    s_waitcnt vmcnt(4)
    ds_read_b64_tr_b16 v[80:81], v8 offset:2048
    ds_read_b64_tr_b16 v[82:83], v8 offset:3072
    ds_read_b64_tr_b16 v[84:85], v9 offset:2048
    ds_read_b64_tr_b16 v[86:87], v9 offset:3072
    s_waitcnt lgkmcnt(4)
    v_mfma_f32_32x32x16_bf16 v[16:31], v[88:91], v[120:123], v[16:31]
    v_mfma_f32_32x32x16_bf16 v[32:47], v[92:95], v[120:123], v[32:47]
    v_mfma_f32_32x32x16_bf16 v[48:63], v[88:91], v[124:127], v[48:63]
    v_mfma_f32_32x32x16_bf16 v[64:79], v[92:95], v[124:127], v[64:79]
    buffer_load_dwordx4 v[120:123], v6, s[24:27], s19 offen
    buffer_load_dwordx4 v[124:127], v6, s[24:27], s42 offen
    s_add_u32 s19, s19, 1024
    s_add_u32 s42, s42, 1024
    s_add_u32 m0, s45, 0
    s_nop 0
    buffer_load_dwordx4 v7, s[28:31], s43 offen lds
    s_add_u32 m0, s45, 1024
    s_add_u32 s43, s43, 8192
    buffer_load_dwordx4 v7, s[28:31], s43 offen lds
    s_add_u32 s43, s43, 8192
    s_waitcnt vmcnt(4)
    ds_read_b64_tr_b16 v[88:89], v8 offset:4096
    ds_read_b64_tr_b16 v[90:91], v8 offset:5120
    ds_read_b64_tr_b16 v[92:93], v9 offset:4096
    ds_read_b64_tr_b16 v[94:95], v9 offset:5120
    s_waitcnt lgkmcnt(4)
    v_mfma_f32_32x32x16_bf16 v[16:31], v[80:83], v[128:131], v[16:31]
    v_mfma_f32_32x32x16_bf16 v[32:47], v[84:87], v[128:131], v[32:47]
    v_mfma_f32_32x32x16_bf16 v[48:63], v[80:83], v[132:135], v[48:63]
    v_mfma_f32_32x32x16_bf16 v[64:79], v[84:87], v[132:135], v[64:79]
    s_add_u32 m0, s45, 2048
    s_nop 0
    buffer_load_dwordx4 v7, s[28:31], s43 offen lds
    s_add_u32 m0, s45, 3072
    s_add_u32 s43, s43, 8192
    buffer_load_dwordx4 v7, s[28:31], s43 offen lds
    s_add_u32 s43, s43, 8192
    s_waitcnt vmcnt(2)
    ds_read_b64_tr_b16 v[80:81], v8 offset:0
    ds_read_b64_tr_b16 v[82:83], v8 offset:1024
    ds_read_b64_tr_b16 v[84:85], v9 offset:0
    ds_read_b64_tr_b16 v[86:87], v9 offset:1024
    s_waitcnt lgkmcnt(4)
    v_mfma_f32_32x32x16_bf16 v[16:31], v[88:91], v[136:139], v[16:31]
    v_mfma_f32_32x32x16_bf16 v[32:47], v[92:95], v[136:139], v[32:47]
    v_mfma_f32_32x32x16_bf16 v[48:63], v[88:91], v[140:143], v[48:63]
    v_mfma_f32_32x32x16_bf16 v[64:79], v[92:95], v[140:143], v[64:79]
    s_add_u32 m0, s45, 4096
    s_nop 0
    buffer_load_dwordx4 v7, s[28:31], s43 offen lds
    s_add_u32 m0, s45, 5120
    s_add_u32 s43, s43, 8192
    buffer_load_dwordx4 v7, s[28:31], s43 offen lds
    s_add_u32 s43, s43, 8192
    s_waitcnt vmcnt(2)
    ds_read_b64_tr_b16 v[88:89], v8 offset:2048
    ds_read_b64_tr_b16 v[90:91], v8 offset:3072
    ds_read_b64_tr_b16 v[92:93], v9 offset:2048
    ds_read_b64_tr_b16 v[94:95], v9 offset:3072
    s_waitcnt lgkmcnt(4)
    v_mfma_f32_32x32x16_bf16 v[16:31], v[80:83], v[96:99], v[16:31]
    v_mfma_f32_32x32x16_bf16 v[32:47], v[84:87], v[96:99], v[32:47]
    v_mfma_f32_32x32x16_bf16 v[48:63], v[80:83], v[100:103], v[48:63]
    v_mfma_f32_32x32x16_bf16 v[64:79], v[84:87], v[100:103], v[64:79]
    s_add_u32 m0, s45, 0
    s_nop 0
    buffer_load_dwordx4 v7, s[28:31], s43 offen lds
    s_add_u32 m0, s45, 1024
    s_add_u32 s43, s43, 8192
    buffer_load_dwordx4 v7, s[28:31], s43 offen lds
    s_add_u32 s43, s43, 8192
    s_waitcnt vmcnt(2)
    ds_read_b64_tr_b16 v[80:81], v8 offset:4096
    ds_read_b64_tr_b16 v[82:83], v8 offset:5120
    ds_read_b64_tr_b16 v[84:85], v9 offset:4096
    ds_read_b64_tr_b16 v[86:87], v9 offset:5120
    s_waitcnt lgkmcnt(4)
    v_mfma_f32_32x32x16_bf16 v[16:31], v[88:91], v[104:107], v[16:31]
    v_mfma_f32_32x32x16_bf16 v[32:47], v[92:95], v[104:107], v[32:47]
    v_mfma_f32_32x32x16_bf16 v[48:63], v[88:91], v[108:111], v[48:63]
    v_mfma_f32_32x32x16_bf16 v[64:79], v[92:95], v[108:111], v[64:79]
    s_waitcnt vmcnt(0)
    ds_read_b64_tr_b16 v[88:89], v8 offset:0
    ds_read_b64_tr_b16 v[90:91], v8 offset:1024
    ds_read_b64_tr_b16 v[92:93], v9 offset:0
    ds_read_b64_tr_b16 v[94:95], v9 offset:1024
    s_waitcnt lgkmcnt(4)
    v_mfma_f32_32x32x16_bf16 v[16:31], v[80:83], v[112:115], v[16:31]
    v_mfma_f32_32x32x16_bf16 v[32:47], v[84:87], v[112:115], v[32:47]
    v_mfma_f32_32x32x16_bf16 v[48:63], v[80:83], v[116:119], v[48:63]
    v_mfma_f32_32x32x16_bf16 v[64:79], v[84:87], v[116:119], v[64:79]
    s_waitcnt lgkmcnt(0)
    v_mfma_f32_32x32x16_bf16 v[16:31], v[88:91], v[120:123], v[16:31]
    v_mfma_f32_32x32x16_bf16 v[32:47], v[92:95], v[120:123], v[32:47]
    v_mfma_f32_32x32x16_bf16 v[48:63], v[88:91], v[124:127], v[48:63]
    v_mfma_f32_32x32x16_bf16 v[64:79], v[92:95], v[124:127], v[64:79]
    s_mov_b32 s32, s64
    s_mov_b32 s33, s65
    s_mov_b32 s34, 2097152
    s_mov_b32 s35, 0x20000
    s_mov_b32 s36, s78
    s_mov_b32 s37, s79
    s_mov_b32 s38, 1024
    s_mov_b32 s39, 0x20000
    s_add_u32 s56, s84, 18907136
    s_addc_u32 s57, s85, 0
    s_mov_b32 s58, 8192
    s_mov_b32 s59, 0x20000
    s_lshr_b32 s11, s16, 1
    s_lshl_b32 s12, s17, 1
    s_add_u32 s46, s11, s12
    s_and_b32 s12, s16, 1
    s_lshl_b32 s12, s12, 6
    s_lshl_b32 s13, s18, 7
    s_add_u32 s47, s12, s13
    s_lshl_b32 s44, s46, 15
    s_add_u32 s44, s44, s47
    v_and_b32 v12, 31, v0
    v_lshlrev_b32 v1, 2, v12
    v_lshlrev_b32 v12, 10, v12
    v_lshrrev_b32 v3, 5, v0
    v_lshlrev_b32 v4, 3, v3
    v_add_u32 v5, v12, v4
    s_lshl_b32 s13, s46, 7
    buffer_load_dword v112, v1, s[56:59], s13 offen
    buffer_load_dwordx2 v[96:97], v5, s[32:35], s44 offen offset:0
    buffer_load_dwordx2 v[104:105], v4, s[36:39], s47 offen offset:0
    buffer_load_dwordx2 v[98:99], v5, s[32:35], s44 offen offset:16
    buffer_load_dwordx2 v[106:107], v4, s[36:39], s47 offen offset:16
    buffer_load_dwordx2 v[100:101], v5, s[32:35], s44 offen offset:32
    buffer_load_dwordx2 v[108:109], v4, s[36:39], s47 offen offset:32
    buffer_load_dwordx2 v[102:103], v5, s[32:35], s44 offen offset:48
    buffer_load_dwordx2 v[110:111], v4, s[36:39], s47 offen offset:48
    v_add_u32 v1, s45, v6
    s_lshl_b32 s13, s16, 2
    s_add_u32 s13, s13, 155648
    v_mov_b32 v2, s13
    s_nop 7
    ds_write_b128 v1, v[32:35] offset:0
    ds_write_b128 v1, v[36:39] offset:1024
    ds_write_b128 v1, v[40:43] offset:2048
    ds_write_b128 v1, v[44:47] offset:3072
    v_mov_b32 v7, 1
    s_waitcnt lgkmcnt(0)
    ds_write_b32 v2, v7
    s_xor_b32 s12, s16, 1
    s_lshl_b32 s13, s12, 2
    s_add_u32 s13, s13, 155648
    v_mov_b32 v3, s13
    s_mul_i32 s12, s12, 6144
    s_add_u32 s12, s12, 131072
    v_add_u32 v4, s12, v6
parallel_sp_14:
    ds_read_b32 v10, v3 offset:0
    s_waitcnt lgkmcnt(0)
    v_readfirstlane_b32 s13, v10
    s_nop 3
    s_cmp_ge_u32 s13, 1
    s_cbranch_scc1 parallel_go_15
    s_sleep 2
    s_branch parallel_sp_14
parallel_go_15:
    ds_read_b128 v[80:83], v4 offset:0
    ds_read_b128 v[84:87], v4 offset:1024
    ds_read_b128 v[88:91], v4 offset:2048
    ds_read_b128 v[92:95], v4 offset:3072
    s_waitcnt lgkmcnt(0)
    ds_write_b32 v3, v7 offset:16
    v_add_f32 v16, v16, v80
    v_add_f32 v17, v17, v81
    v_add_f32 v18, v18, v82
    v_add_f32 v19, v19, v83
    v_add_f32 v20, v20, v84
    v_add_f32 v21, v21, v85
    v_add_f32 v22, v22, v86
    v_add_f32 v23, v23, v87
    v_add_f32 v24, v24, v88
    v_add_f32 v25, v25, v89
    v_add_f32 v26, v26, v90
    v_add_f32 v27, v27, v91
    v_add_f32 v28, v28, v92
    v_add_f32 v29, v29, v93
    v_add_f32 v30, v30, v94
    v_add_f32 v31, v31, v95
parallel_sp_16:
    ds_read_b32 v10, v2 offset:16
    s_waitcnt lgkmcnt(0)
    v_readfirstlane_b32 s13, v10
    s_nop 3
    s_cmp_ge_u32 s13, 1
    s_cbranch_scc1 parallel_go_17
    s_sleep 2
    s_branch parallel_sp_16
parallel_go_17:
    ds_write_b128 v1, v[64:67] offset:0
    ds_write_b128 v1, v[68:71] offset:1024
    ds_write_b128 v1, v[72:75] offset:2048
    ds_write_b128 v1, v[76:79] offset:3072
    v_mov_b32 v7, 2
    s_waitcnt lgkmcnt(0)
    ds_write_b32 v2, v7
    s_xor_b32 s12, s16, 1
    s_lshl_b32 s13, s12, 2
    s_add_u32 s13, s13, 155648
    v_mov_b32 v3, s13
    s_mul_i32 s12, s12, 6144
    s_add_u32 s12, s12, 131072
    v_add_u32 v4, s12, v6
parallel_sp_18:
    ds_read_b32 v10, v3 offset:0
    s_waitcnt lgkmcnt(0)
    v_readfirstlane_b32 s13, v10
    s_nop 3
    s_cmp_ge_u32 s13, 2
    s_cbranch_scc1 parallel_go_19
    s_sleep 2
    s_branch parallel_sp_18
parallel_go_19:
    ds_read_b128 v[80:83], v4 offset:0
    ds_read_b128 v[84:87], v4 offset:1024
    ds_read_b128 v[88:91], v4 offset:2048
    ds_read_b128 v[92:95], v4 offset:3072
    s_waitcnt lgkmcnt(0)
    ds_write_b32 v3, v7 offset:16
    v_add_f32 v48, v48, v80
    v_add_f32 v49, v49, v81
    v_add_f32 v50, v50, v82
    v_add_f32 v51, v51, v83
    v_add_f32 v52, v52, v84
    v_add_f32 v53, v53, v85
    v_add_f32 v54, v54, v86
    v_add_f32 v55, v55, v87
    v_add_f32 v56, v56, v88
    v_add_f32 v57, v57, v89
    v_add_f32 v58, v58, v90
    v_add_f32 v59, v59, v91
    v_add_f32 v60, v60, v92
    v_add_f32 v61, v61, v93
    v_add_f32 v62, v62, v94
    v_add_f32 v63, v63, v95
parallel_sp_20:
    ds_read_b32 v10, v2 offset:16
    s_waitcnt lgkmcnt(0)
    v_readfirstlane_b32 s13, v10
    s_nop 3
    s_cmp_ge_u32 s13, 2
    s_cbranch_scc1 parallel_go_21
    s_sleep 2
    s_branch parallel_sp_20
parallel_go_21:
    ds_write_b128 v1, v[48:51] offset:0
    ds_write_b128 v1, v[52:55] offset:1024
    ds_write_b128 v1, v[56:59] offset:2048
    ds_write_b128 v1, v[60:63] offset:3072
    v_mov_b32 v7, 3
    s_waitcnt lgkmcnt(0)
    ds_write_b32 v2, v7
    s_xor_b32 s12, s16, 2
    s_lshl_b32 s13, s12, 2
    s_add_u32 s13, s13, 155648
    v_mov_b32 v3, s13
    s_mul_i32 s12, s12, 6144
    s_add_u32 s12, s12, 131072
    v_add_u32 v4, s12, v6
parallel_sp_22:
    ds_read_b32 v10, v3 offset:0
    s_waitcnt lgkmcnt(0)
    v_readfirstlane_b32 s13, v10
    s_nop 3
    s_cmp_ge_u32 s13, 3
    s_cbranch_scc1 parallel_go_23
    s_sleep 2
    s_branch parallel_sp_22
parallel_go_23:
    ds_read_b128 v[80:83], v4 offset:0
    ds_read_b128 v[84:87], v4 offset:1024
    ds_read_b128 v[88:91], v4 offset:2048
    ds_read_b128 v[92:95], v4 offset:3072
    s_waitcnt lgkmcnt(0)
    ds_write_b32 v3, v7 offset:16
    v_add_f32 v16, v16, v80
    v_add_f32 v17, v17, v81
    v_add_f32 v18, v18, v82
    v_add_f32 v19, v19, v83
    v_add_f32 v20, v20, v84
    v_add_f32 v21, v21, v85
    v_add_f32 v22, v22, v86
    v_add_f32 v23, v23, v87
    v_add_f32 v24, v24, v88
    v_add_f32 v25, v25, v89
    v_add_f32 v26, v26, v90
    v_add_f32 v27, v27, v91
    v_add_f32 v28, v28, v92
    v_add_f32 v29, v29, v93
    v_add_f32 v30, v30, v94
    v_add_f32 v31, v31, v95
    s_waitcnt vmcnt(0)
    v_mul_f32 v112, v112, v112
    v_mul_f32 v16, v16, v112
    v_mul_f32 v17, v17, v112
    v_mul_f32 v18, v18, v112
    v_mul_f32 v19, v19, v112
    v_mul_f32 v20, v20, v112
    v_mul_f32 v21, v21, v112
    v_mul_f32 v22, v22, v112
    v_mul_f32 v23, v23, v112
    v_mul_f32 v24, v24, v112
    v_mul_f32 v25, v25, v112
    v_mul_f32 v26, v26, v112
    v_mul_f32 v27, v27, v112
    v_mul_f32 v28, v28, v112
    v_mul_f32 v29, v29, v112
    v_mul_f32 v30, v30, v112
    v_mul_f32 v31, v31, v112
    v_lshlrev_b32 v1, 16, v96
    v_and_b32 v7, 0xffff0000, v96
    v_add_f32 v16, v16, v1
    v_add_f32 v17, v17, v7
    v_lshlrev_b32 v1, 16, v104
    v_and_b32 v7, 0xffff0000, v104
    v_add_f32 v16, v16, v1
    v_add_f32 v17, v17, v7
    v_lshlrev_b32 v1, 16, v97
    v_and_b32 v7, 0xffff0000, v97
    v_add_f32 v18, v18, v1
    v_add_f32 v19, v19, v7
    v_lshlrev_b32 v1, 16, v105
    v_and_b32 v7, 0xffff0000, v105
    v_add_f32 v18, v18, v1
    v_add_f32 v19, v19, v7
    v_lshlrev_b32 v1, 16, v98
    v_and_b32 v7, 0xffff0000, v98
    v_add_f32 v20, v20, v1
    v_add_f32 v21, v21, v7
    v_lshlrev_b32 v1, 16, v106
    v_and_b32 v7, 0xffff0000, v106
    v_add_f32 v20, v20, v1
    v_add_f32 v21, v21, v7
    v_lshlrev_b32 v1, 16, v99
    v_and_b32 v7, 0xffff0000, v99
    v_add_f32 v22, v22, v1
    v_add_f32 v23, v23, v7
    v_lshlrev_b32 v1, 16, v107
    v_and_b32 v7, 0xffff0000, v107
    v_add_f32 v22, v22, v1
    v_add_f32 v23, v23, v7
    v_lshlrev_b32 v1, 16, v100
    v_and_b32 v7, 0xffff0000, v100
    v_add_f32 v24, v24, v1
    v_add_f32 v25, v25, v7
    v_lshlrev_b32 v1, 16, v108
    v_and_b32 v7, 0xffff0000, v108
    v_add_f32 v24, v24, v1
    v_add_f32 v25, v25, v7
    v_lshlrev_b32 v1, 16, v101
    v_and_b32 v7, 0xffff0000, v101
    v_add_f32 v26, v26, v1
    v_add_f32 v27, v27, v7
    v_lshlrev_b32 v1, 16, v109
    v_and_b32 v7, 0xffff0000, v109
    v_add_f32 v26, v26, v1
    v_add_f32 v27, v27, v7
    v_lshlrev_b32 v1, 16, v102
    v_and_b32 v7, 0xffff0000, v102
    v_add_f32 v28, v28, v1
    v_add_f32 v29, v29, v7
    v_lshlrev_b32 v1, 16, v110
    v_and_b32 v7, 0xffff0000, v110
    v_add_f32 v28, v28, v1
    v_add_f32 v29, v29, v7
    v_lshlrev_b32 v1, 16, v103
    v_and_b32 v7, 0xffff0000, v103
    v_add_f32 v30, v30, v1
    v_add_f32 v31, v31, v7
    v_lshlrev_b32 v1, 16, v111
    v_and_b32 v7, 0xffff0000, v111
    v_add_f32 v30, v30, v1
    v_add_f32 v31, v31, v7
    s_lshl_b32 s13, s16, 2
    s_add_u32 s13, s13, 155648
    v_mov_b32 v2, s13
parallel_sp_24:
    ds_read_b32 v10, v2 offset:16
    s_waitcnt lgkmcnt(0)
    v_readfirstlane_b32 s13, v10
    s_nop 3
    s_cmp_ge_u32 s13, 3
    s_cbranch_scc1 parallel_go_25
    s_sleep 2
    s_branch parallel_sp_24
parallel_go_25:
    s_mov_b32 s28, s68
    s_mov_b32 s29, s69
    s_mov_b32 s30, 524288
    s_mov_b32 s31, 0x20000
    s_mov_b32 s32, s80
    s_mov_b32 s33, s81
    s_mov_b32 s34, 2097152
    s_mov_b32 s35, 0x20000
    v_lshrrev_b32 v1, 3, v0
    v_and_b32 v2, 7, v0
    v_bfe_u32 v3, v0, 4, 1
    v_lshlrev_b32 v3, 2, v3
    v_xor_b32 v2, v2, v3
    v_lshlrev_b32 v2, 4, v2
    v_lshl_add_u32 v7, v1, 10, v2
    s_barrier
    s_barrier
    s_barrier
    s_cmp_lg_u32 s16, 0
    s_cbranch_scc1 parallel_wofetch
    s_mul_i32 s14, s22, 512
    s_add_u32 s14, s14, 12288
    v_lshlrev_b32 v3, 7, v0
    v_mov_b32 v2, 1
    s_mov_b64 exec, 0xf
    buffer_atomic_add v2, v3, s[48:51], s14 offen sc1
    s_mov_b64 exec, -1
    s_branch parallel_wodone
parallel_wofetch:
    s_sub_u32 s10, s16, 1
    s_mul_i32 s10, s10, 21
    s_cmp_gt_u32 s16, 1
    s_addc_u32 s10, s10, 0
    s_lshl_b32 s11, s10, 13
    s_lshl_b32 s12, s18, 7
    s_add_u32 s11, s11, s12
    s_lshl_b32 s10, s10, 10
    s_add_u32 m0, s10, 0
    s_nop 0
    buffer_load_dwordx4 v7, s[28:31], s11 offen lds
    s_add_u32 s11, s11, 8192
    s_add_u32 m0, s10, 1024
    s_nop 0
    buffer_load_dwordx4 v7, s[28:31], s11 offen lds
    s_add_u32 s11, s11, 8192
    s_add_u32 m0, s10, 2048
    s_nop 0
    buffer_load_dwordx4 v7, s[28:31], s11 offen lds
    s_add_u32 s11, s11, 8192
    s_add_u32 m0, s10, 3072
    s_nop 0
    buffer_load_dwordx4 v7, s[28:31], s11 offen lds
    s_add_u32 s11, s11, 8192
    s_add_u32 m0, s10, 4096
    s_nop 0
    buffer_load_dwordx4 v7, s[28:31], s11 offen lds
    s_add_u32 s11, s11, 8192
    s_add_u32 m0, s10, 5120
    s_nop 0
    buffer_load_dwordx4 v7, s[28:31], s11 offen lds
    s_add_u32 s11, s11, 8192
    s_add_u32 m0, s10, 6144
    s_nop 0
    buffer_load_dwordx4 v7, s[28:31], s11 offen lds
    s_add_u32 s11, s11, 8192
    s_add_u32 m0, s10, 7168
    s_nop 0
    buffer_load_dwordx4 v7, s[28:31], s11 offen lds
    s_add_u32 s11, s11, 8192
    s_add_u32 m0, s10, 8192
    s_nop 0
    buffer_load_dwordx4 v7, s[28:31], s11 offen lds
    s_add_u32 s11, s11, 8192
    s_add_u32 m0, s10, 9216
    s_nop 0
    buffer_load_dwordx4 v7, s[28:31], s11 offen lds
    s_add_u32 s11, s11, 8192
    s_add_u32 m0, s10, 10240
    s_nop 0
    buffer_load_dwordx4 v7, s[28:31], s11 offen lds
    s_add_u32 s11, s11, 8192
    s_add_u32 m0, s10, 11264
    s_nop 0
    buffer_load_dwordx4 v7, s[28:31], s11 offen lds
    s_add_u32 s11, s11, 8192
    s_add_u32 m0, s10, 12288
    s_nop 0
    buffer_load_dwordx4 v7, s[28:31], s11 offen lds
    s_add_u32 s11, s11, 8192
    s_add_u32 m0, s10, 13312
    s_nop 0
    buffer_load_dwordx4 v7, s[28:31], s11 offen lds
    s_add_u32 s11, s11, 8192
    s_add_u32 m0, s10, 14336
    s_nop 0
    buffer_load_dwordx4 v7, s[28:31], s11 offen lds
    s_add_u32 s11, s11, 8192
    s_add_u32 m0, s10, 15360
    s_nop 0
    buffer_load_dwordx4 v7, s[28:31], s11 offen lds
    s_add_u32 s11, s11, 8192
    s_add_u32 m0, s10, 16384
    s_nop 0
    buffer_load_dwordx4 v7, s[28:31], s11 offen lds
    s_add_u32 s11, s11, 8192
    s_add_u32 m0, s10, 17408
    s_nop 0
    buffer_load_dwordx4 v7, s[28:31], s11 offen lds
    s_add_u32 s11, s11, 8192
    s_add_u32 m0, s10, 18432
    s_nop 0
    buffer_load_dwordx4 v7, s[28:31], s11 offen lds
    s_add_u32 s11, s11, 8192
    s_add_u32 m0, s10, 19456
    s_nop 0
    buffer_load_dwordx4 v7, s[28:31], s11 offen lds
    s_add_u32 s11, s11, 8192
    s_add_u32 m0, s10, 20480
    s_nop 0
    buffer_load_dwordx4 v7, s[28:31], s11 offen lds
    s_add_u32 s11, s11, 8192
    s_cmp_lg_u32 s16, 1
    s_cbranch_scc1 parallel_wodone
    s_add_u32 m0, s10, 21504
    s_nop 0
    buffer_load_dwordx4 v7, s[28:31], s11 offen lds
    s_add_u32 s11, s11, 8192
parallel_wodone:
    s_cmp_lg_u32 s16, 0
    s_cbranch_scc1 parallel_nosig
    s_mul_i32 s14, s22, 512
    s_add_u32 s14, s14, 12288
    s_and_b32 s12, s21, 3
    s_lshl_b32 s12, s12, 7
    s_add_u32 s14, s14, s12
    v_mov_b32 v10, 0
parallel_pl_26:
    buffer_load_dword v5, v10, s[48:51], s14 offen sc1
    s_waitcnt vmcnt(0)
    v_readfirstlane_b32 s13, v5
    s_nop 3
    s_cmp_ge_u32 s13, 32
    s_cbranch_scc1 parallel_pk_27
    s_sleep 1
    s_branch parallel_pl_26
parallel_pk_27:
parallel_nosig:
    s_waitcnt vmcnt(0)
    s_barrier
    s_mul_i32 s10, s17, 294912
    s_lshl_b32 s11, s16, 11
    s_add_u32 s10, s10, s11
    s_add_u32 s11, s11, 65536
    s_add_u32 m0, s11, 0
    s_add_u32 s12, s10, 0
    buffer_load_dwordx4 v6, s[24:27], s12 offen lds
    s_add_u32 m0, s11, 1024
    s_add_u32 s12, s10, 1024
    buffer_load_dwordx4 v6, s[24:27], s12 offen lds
    s_add_u32 m0, s11, 32768
    s_add_u32 s12, s10, 147456
    buffer_load_dwordx4 v6, s[24:27], s12 offen lds
    s_add_u32 m0, s11, 33792
    s_add_u32 s12, s10, 148480
    buffer_load_dwordx4 v6, s[24:27], s12 offen lds
    s_add_u32 m0, s11, 8192
    s_add_u32 s12, s10, 8192
    buffer_load_dwordx4 v6, s[24:27], s12 offen lds
    s_add_u32 m0, s11, 9216
    s_add_u32 s12, s10, 9216
    buffer_load_dwordx4 v6, s[24:27], s12 offen lds
    s_add_u32 m0, s11, 40960
    s_add_u32 s12, s10, 155648
    buffer_load_dwordx4 v6, s[24:27], s12 offen lds
    s_add_u32 m0, s11, 41984
    s_add_u32 s12, s10, 156672
    buffer_load_dwordx4 v6, s[24:27], s12 offen lds
    s_add_u32 m0, s11, 16384
    s_add_u32 s12, s10, 16384
    buffer_load_dwordx4 v6, s[24:27], s12 offen lds
    s_add_u32 m0, s11, 17408
    s_add_u32 s12, s10, 17408
    buffer_load_dwordx4 v6, s[24:27], s12 offen lds
    s_add_u32 m0, s11, 49152
    s_add_u32 s12, s10, 163840
    buffer_load_dwordx4 v6, s[24:27], s12 offen lds
    s_add_u32 m0, s11, 50176
    s_add_u32 s12, s10, 164864
    buffer_load_dwordx4 v6, s[24:27], s12 offen lds
    s_add_u32 m0, s11, 24576
    s_add_u32 s12, s10, 24576
    buffer_load_dwordx4 v6, s[24:27], s12 offen lds
    s_add_u32 m0, s11, 25600
    s_add_u32 s12, s10, 25600
    buffer_load_dwordx4 v6, s[24:27], s12 offen lds
    s_add_u32 m0, s11, 57344
    s_add_u32 s12, s10, 172032
    buffer_load_dwordx4 v6, s[24:27], s12 offen lds
    s_add_u32 m0, s11, 58368
    s_add_u32 s12, s10, 173056
    buffer_load_dwordx4 v6, s[24:27], s12 offen lds
    s_lshr_b32 s11, s16, 1
    s_lshl_b32 s11, s11, 15
    s_add_u32 s11, s11, 65536
    v_add_u32 v1, s11, v6
    s_waitcnt vmcnt(12)
    s_barrier
    ds_read_b128 v[96:99], v1 offset:0
    ds_read_b64_tr_b16 v[104:105], v11 offset:0
    ds_read_b64_tr_b16 v[106:107], v11 offset:1024
    ds_read_b128 v[100:103], v1 offset:1024
    ds_read_b64_tr_b16 v[108:109], v11 offset:2048
    ds_read_b64_tr_b16 v[110:111], v11 offset:3072
    s_waitcnt lgkmcnt(3)
    v_mfma_f32_32x32x16_bf16 v[16:31], v[104:107], v[96:99], v[16:31]
    ds_read_b128 v[96:99], v1 offset:2048
    ds_read_b64_tr_b16 v[104:105], v11 offset:4096
    ds_read_b64_tr_b16 v[106:107], v11 offset:5120
    s_waitcnt lgkmcnt(3)
    v_mfma_f32_32x32x16_bf16 v[16:31], v[108:111], v[100:103], v[16:31]
    ds_read_b128 v[100:103], v1 offset:3072
    ds_read_b64_tr_b16 v[108:109], v11 offset:6144
    ds_read_b64_tr_b16 v[110:111], v11 offset:7168
    s_waitcnt lgkmcnt(3)
    v_mfma_f32_32x32x16_bf16 v[16:31], v[104:107], v[96:99], v[16:31]
    ds_read_b128 v[96:99], v1 offset:4096
    ds_read_b64_tr_b16 v[104:105], v11 offset:8192
    ds_read_b64_tr_b16 v[106:107], v11 offset:9216
    s_waitcnt lgkmcnt(3)
    v_mfma_f32_32x32x16_bf16 v[16:31], v[108:111], v[100:103], v[16:31]
    ds_read_b128 v[100:103], v1 offset:5120
    ds_read_b64_tr_b16 v[108:109], v11 offset:10240
    ds_read_b64_tr_b16 v[110:111], v11 offset:11264
    s_waitcnt lgkmcnt(3)
    v_mfma_f32_32x32x16_bf16 v[16:31], v[104:107], v[96:99], v[16:31]
    ds_read_b128 v[96:99], v1 offset:6144
    ds_read_b64_tr_b16 v[104:105], v11 offset:12288
    ds_read_b64_tr_b16 v[106:107], v11 offset:13312
    s_waitcnt lgkmcnt(3)
    v_mfma_f32_32x32x16_bf16 v[16:31], v[108:111], v[100:103], v[16:31]
    ds_read_b128 v[100:103], v1 offset:7168
    ds_read_b64_tr_b16 v[108:109], v11 offset:14336
    ds_read_b64_tr_b16 v[110:111], v11 offset:15360
    s_waitcnt lgkmcnt(3)
    v_mfma_f32_32x32x16_bf16 v[16:31], v[104:107], v[96:99], v[16:31]
    s_waitcnt lgkmcnt(0)
    v_mfma_f32_32x32x16_bf16 v[16:31], v[108:111], v[100:103], v[16:31]
    s_waitcnt vmcnt(8)
    s_barrier
    ds_read_b128 v[96:99], v1 offset:8192
    ds_read_b64_tr_b16 v[104:105], v11 offset:16384
    ds_read_b64_tr_b16 v[106:107], v11 offset:17408
    ds_read_b128 v[100:103], v1 offset:9216
    ds_read_b64_tr_b16 v[108:109], v11 offset:18432
    ds_read_b64_tr_b16 v[110:111], v11 offset:19456
    s_waitcnt lgkmcnt(3)
    v_mfma_f32_32x32x16_bf16 v[16:31], v[104:107], v[96:99], v[16:31]
    ds_read_b128 v[96:99], v1 offset:10240
    ds_read_b64_tr_b16 v[104:105], v11 offset:20480
    ds_read_b64_tr_b16 v[106:107], v11 offset:21504
    s_waitcnt lgkmcnt(3)
    v_mfma_f32_32x32x16_bf16 v[16:31], v[108:111], v[100:103], v[16:31]
    ds_read_b128 v[100:103], v1 offset:11264
    ds_read_b64_tr_b16 v[108:109], v11 offset:22528
    ds_read_b64_tr_b16 v[110:111], v11 offset:23552
    s_waitcnt lgkmcnt(3)
    v_mfma_f32_32x32x16_bf16 v[16:31], v[104:107], v[96:99], v[16:31]
    ds_read_b128 v[96:99], v1 offset:12288
    ds_read_b64_tr_b16 v[104:105], v11 offset:24576
    ds_read_b64_tr_b16 v[106:107], v11 offset:25600
    s_waitcnt lgkmcnt(3)
    v_mfma_f32_32x32x16_bf16 v[16:31], v[108:111], v[100:103], v[16:31]
    ds_read_b128 v[100:103], v1 offset:13312
    ds_read_b64_tr_b16 v[108:109], v11 offset:26624
    ds_read_b64_tr_b16 v[110:111], v11 offset:27648
    s_waitcnt lgkmcnt(3)
    v_mfma_f32_32x32x16_bf16 v[16:31], v[104:107], v[96:99], v[16:31]
    ds_read_b128 v[96:99], v1 offset:14336
    ds_read_b64_tr_b16 v[104:105], v11 offset:28672
    ds_read_b64_tr_b16 v[106:107], v11 offset:29696
    s_waitcnt lgkmcnt(3)
    v_mfma_f32_32x32x16_bf16 v[16:31], v[108:111], v[100:103], v[16:31]
    ds_read_b128 v[100:103], v1 offset:15360
    ds_read_b64_tr_b16 v[108:109], v11 offset:30720
    ds_read_b64_tr_b16 v[110:111], v11 offset:31744
    s_waitcnt lgkmcnt(3)
    v_mfma_f32_32x32x16_bf16 v[16:31], v[104:107], v[96:99], v[16:31]
    s_waitcnt lgkmcnt(0)
    v_mfma_f32_32x32x16_bf16 v[16:31], v[108:111], v[100:103], v[16:31]
    s_waitcnt vmcnt(4)
    s_barrier
    ds_read_b128 v[96:99], v1 offset:16384
    ds_read_b64_tr_b16 v[104:105], v11 offset:32768
    ds_read_b64_tr_b16 v[106:107], v11 offset:33792
    ds_read_b128 v[100:103], v1 offset:17408
    ds_read_b64_tr_b16 v[108:109], v11 offset:34816
    ds_read_b64_tr_b16 v[110:111], v11 offset:35840
    s_waitcnt lgkmcnt(3)
    v_mfma_f32_32x32x16_bf16 v[16:31], v[104:107], v[96:99], v[16:31]
    ds_read_b128 v[96:99], v1 offset:18432
    ds_read_b64_tr_b16 v[104:105], v11 offset:36864
    ds_read_b64_tr_b16 v[106:107], v11 offset:37888
    s_waitcnt lgkmcnt(3)
    v_mfma_f32_32x32x16_bf16 v[16:31], v[108:111], v[100:103], v[16:31]
    ds_read_b128 v[100:103], v1 offset:19456
    ds_read_b64_tr_b16 v[108:109], v11 offset:38912
    ds_read_b64_tr_b16 v[110:111], v11 offset:39936
    s_waitcnt lgkmcnt(3)
    v_mfma_f32_32x32x16_bf16 v[16:31], v[104:107], v[96:99], v[16:31]
    ds_read_b128 v[96:99], v1 offset:20480
    ds_read_b64_tr_b16 v[104:105], v11 offset:40960
    ds_read_b64_tr_b16 v[106:107], v11 offset:41984
    s_waitcnt lgkmcnt(3)
    v_mfma_f32_32x32x16_bf16 v[16:31], v[108:111], v[100:103], v[16:31]
    ds_read_b128 v[100:103], v1 offset:21504
    ds_read_b64_tr_b16 v[108:109], v11 offset:43008
    ds_read_b64_tr_b16 v[110:111], v11 offset:44032
    s_waitcnt lgkmcnt(3)
    v_mfma_f32_32x32x16_bf16 v[16:31], v[104:107], v[96:99], v[16:31]
    ds_read_b128 v[96:99], v1 offset:22528
    ds_read_b64_tr_b16 v[104:105], v11 offset:45056
    ds_read_b64_tr_b16 v[106:107], v11 offset:46080
    s_waitcnt lgkmcnt(3)
    v_mfma_f32_32x32x16_bf16 v[16:31], v[108:111], v[100:103], v[16:31]
    ds_read_b128 v[100:103], v1 offset:23552
    ds_read_b64_tr_b16 v[108:109], v11 offset:47104
    ds_read_b64_tr_b16 v[110:111], v11 offset:48128
    s_waitcnt lgkmcnt(3)
    v_mfma_f32_32x32x16_bf16 v[16:31], v[104:107], v[96:99], v[16:31]
    s_waitcnt lgkmcnt(0)
    v_mfma_f32_32x32x16_bf16 v[16:31], v[108:111], v[100:103], v[16:31]
    s_waitcnt vmcnt(0)
    s_barrier
    ds_read_b128 v[96:99], v1 offset:24576
    ds_read_b64_tr_b16 v[104:105], v11 offset:49152
    ds_read_b64_tr_b16 v[106:107], v11 offset:50176
    ds_read_b128 v[100:103], v1 offset:25600
    ds_read_b64_tr_b16 v[108:109], v11 offset:51200
    ds_read_b64_tr_b16 v[110:111], v11 offset:52224
    s_waitcnt lgkmcnt(3)
    v_mfma_f32_32x32x16_bf16 v[16:31], v[104:107], v[96:99], v[16:31]
    ds_read_b128 v[96:99], v1 offset:26624
    ds_read_b64_tr_b16 v[104:105], v11 offset:53248
    ds_read_b64_tr_b16 v[106:107], v11 offset:54272
    s_waitcnt lgkmcnt(3)
    v_mfma_f32_32x32x16_bf16 v[16:31], v[108:111], v[100:103], v[16:31]
    ds_read_b128 v[100:103], v1 offset:27648
    ds_read_b64_tr_b16 v[108:109], v11 offset:55296
    ds_read_b64_tr_b16 v[110:111], v11 offset:56320
    s_waitcnt lgkmcnt(3)
    v_mfma_f32_32x32x16_bf16 v[16:31], v[104:107], v[96:99], v[16:31]
    ds_read_b128 v[96:99], v1 offset:28672
    ds_read_b64_tr_b16 v[104:105], v11 offset:57344
    ds_read_b64_tr_b16 v[106:107], v11 offset:58368
    s_waitcnt lgkmcnt(3)
    v_mfma_f32_32x32x16_bf16 v[16:31], v[108:111], v[100:103], v[16:31]
    ds_read_b128 v[100:103], v1 offset:29696
    ds_read_b64_tr_b16 v[108:109], v11 offset:59392
    ds_read_b64_tr_b16 v[110:111], v11 offset:60416
    s_waitcnt lgkmcnt(3)
    v_mfma_f32_32x32x16_bf16 v[16:31], v[104:107], v[96:99], v[16:31]
    ds_read_b128 v[96:99], v1 offset:30720
    ds_read_b64_tr_b16 v[104:105], v11 offset:61440
    ds_read_b64_tr_b16 v[106:107], v11 offset:62464
    s_waitcnt lgkmcnt(3)
    v_mfma_f32_32x32x16_bf16 v[16:31], v[108:111], v[100:103], v[16:31]
    ds_read_b128 v[100:103], v1 offset:31744
    ds_read_b64_tr_b16 v[108:109], v11 offset:63488
    ds_read_b64_tr_b16 v[110:111], v11 offset:64512
    s_waitcnt lgkmcnt(3)
    v_mfma_f32_32x32x16_bf16 v[16:31], v[104:107], v[96:99], v[16:31]
    s_waitcnt lgkmcnt(0)
    v_mfma_f32_32x32x16_bf16 v[16:31], v[108:111], v[100:103], v[16:31]
    s_nop 7
    s_nop 3
    v_cvt_pk_bf16_f32 v80, v16, v17
    v_cvt_pk_bf16_f32 v81, v18, v19
    v_cvt_pk_bf16_f32 v82, v20, v21
    v_cvt_pk_bf16_f32 v83, v22, v23
    v_cvt_pk_bf16_f32 v84, v24, v25
    v_cvt_pk_bf16_f32 v85, v26, v27
    v_cvt_pk_bf16_f32 v86, v28, v29
    v_cvt_pk_bf16_f32 v87, v30, v31
    s_nop 1
    v_permlane32_swap_b32 v80, v82
    v_permlane32_swap_b32 v81, v83
    v_permlane32_swap_b32 v84, v86
    v_permlane32_swap_b32 v85, v87
    v_lshrrev_b32 v3, 5, v0
    v_lshlrev_b32 v4, 4, v3
    v_add_u32 v5, v12, v4
    buffer_store_dwordx4 v[80:83], v5, s[32:35], s44 offen offset:0
    buffer_store_dwordx4 v[84:87], v5, s[32:35], s44 offen offset:32
parallel_end:
    s_endpgm
.section .rodata,"a"
.p2align 6
.amdhsa_kernel parallel_sum__softmax_full_mha__dense_activation_squared_relu__prompt_kernel
  .amdhsa_next_free_vgpr 168
  .amdhsa_next_free_sgpr 102
  .amdhsa_accum_offset 168
  .amdhsa_group_segment_fixed_size 0
  .amdhsa_kernarg_size 88
  .amdhsa_user_sgpr_count 2
  .amdhsa_user_sgpr_kernarg_segment_ptr 1
  .amdhsa_system_sgpr_workgroup_id_x 1
  .amdhsa_float_denorm_mode_32 3
.end_amdhsa_kernel
```
